```python
import torch

def _softmax(x, axis=-1):
    return torch.softmax(x, dim=axis)
def _gelu(x):
    return torch.nn.functional.gelu(x, approximate="tanh")
def _silu(x):
    return torch.nn.functional.silu(x)
def _sigmoid(x):
    return torch.sigmoid(x)
def _layernorm(x, axis=-1, eps=1e-5):
    m = x.mean(dim=axis, keepdim=True)
    v = x.var(dim=axis, keepdim=True, unbiased=False)
    return (x - m) / torch.sqrt(v + eps)
def _scatter_add(tgt, idx, src, axis=0):
    return tgt.clone().index_add_(axis, idx, src)
def _segment_sum(src, seg, n):
    out = torch.zeros((n,) + src.shape[1:], dtype=src.dtype)
    return out.index_add_(0, seg, src)
def _pad(x, pw):
    flat = tuple(v for pair in reversed(pw) for v in pair)
    return torch.nn.functional.pad(x, flat)

kernel_name = 'standalone__edge_featured_mpnn_gatedgcn__graph'

def setup_inputs():

    _w = (lambda a: (lambda t: t.to(torch.bfloat16) if t.is_floating_point() else t)(torch.as_tensor(a)))
    N, deg, D, De = 10000, 16, 256, max(0, 1)
    E = N * deg
    return {
        "x": _w((lambda *s: torch.randn(*s, dtype=torch.bfloat16) * 0.4)(N, D)),
        "e_attr": _w((lambda *s: torch.randn(*s, dtype=torch.bfloat16) * 0.8)(E, De)),
        "src": _w((lambda lo, hi, *s: torch.randint(lo, hi, s))(0, N, E).to(torch.int64)),
        "dst": _w((lambda lo, hi, *s: torch.randint(lo, hi, s))(0, N, E).to(torch.int64)),
        "w_a": _w((lambda *s: torch.randn(*s, dtype=torch.bfloat16) * 0.4)(D, D)),
        "w_b": _w((lambda *s: torch.randn(*s, dtype=torch.bfloat16) * 0.4)(D, D)),
        "w_c": _w((lambda *s: torch.randn(*s, dtype=torch.bfloat16) * 0.8)(De, D)),
        "w_u": _w((lambda *s: torch.randn(*s, dtype=torch.bfloat16) * 0.05)(D, D)),
        "w_v": _w((lambda *s: torch.randn(*s, dtype=torch.bfloat16) * 0.05)(D, D)),
    }

def reference(x, e_attr, src, dst, w_a, w_b, w_c, w_u, w_v):
    N, D = x.shape
    hv = x @ w_v
    g = x[dst] @ w_a + x[src] @ w_b + e_attr @ w_c
    eta = _sigmoid(g)
    denom = _segment_sum(eta, dst, N) + 1e-6
    eta_n = eta / denom[dst]
    agg = _segment_sum(eta_n * hv[src], dst, N)
    z = x @ w_u + agg
    relu_z = torch.where(z > 0, z, 0 * z)
    return x + relu_z
```

```asm
; @launch kernel=standalone__edge_featured_mpnn_gatedgcn__graph_kernel grid=(256,1,1) block=(1024,1,1) lds=163840
.amdgcn_target "amdgcn-amd-amdhsa--gfx950"
.text
.globl standalone__edge_featured_mpnn_gatedgcn__graph_kernel
.p2align 12
.p2align 8
.type standalone__edge_featured_mpnn_gatedgcn__graph_kernel,@function
standalone__edge_featured_mpnn_gatedgcn__graph_kernel:
    s_load_dwordx16 s[4:19], s[0:1], 0
    s_load_dwordx8 s[20:27], s[0:1], 64
    s_cmp_ge_u32 s2, 256
    s_cbranch_scc1 K_exit
    v_lshrrev_b32 v1, 6, v0
    v_lshlrev_b32 v13, 4, v0
    v_readfirstlane_b32 s3, v1
    v_mov_b64 v[4:5], 0
    v_mov_b64 v[6:7], 0
    v_cmpx_gt_u32 vcc, 96, v0
    ds_write_b128 v13, v[4:7]
    s_mov_b64 exec, -1
    v_and_b32 v0, 63, v0
    s_setprio 3
    s_and_b32 s53, s2, 3
    s_lshr_b32 s52, s2, 3
    s_and_b32 s61, s2, 4
    s_lshl3_add_u32 s100, s61, s52
    s_mul_i32 s52, s100, 158
    s_and_b32 s55, s3, 3
    s_lshr_b32 s54, s3, 2
    s_mov_b32 s60, 16777216
    s_mov_b32 s62, 8192
    s_mov_b32 s34, 0x10000000
    s_mov_b32 s35, 0x00020000
    s_mov_b32 s38, 0x20000
    s_mov_b32 s39, 0x00020000
    s_mov_b32 s30, 5120000
    s_mov_b32 s31, 0x00020000
    v_and_b32 v14, 48, v0
    v_and_b32 v16, 8, v0
    v_and_b32 v17, 7, v0
    v_lshlrev_b32 v17, 4, v17
    v_lshl_add_u32 v17, v16, 6, v17
    v_lshl_add_u32 v2, v14, 8, v17
    s_and_b32 s64, s55, 1
    s_lshl_b32 s61, s64, 6
    v_xor_b32 v2, s61, v2
    v_xor_b32 v15, 32, v2
    s_lshl_b32 s64, s64, 12
    s_add_u32 s64, s64, 15104
    s_lshl_b32 s63, s53, 7
    s_bfe_u32 s66, s2, 0x20003
    s_add_u32 s66, s66, s54
    s_lshl_b32 s66, s66, 1
    s_lshr_b32 s61, s55, 1
    s_add_u32 s66, s66, s61
    s_cmp_eq_u32 s54, 0
    s_cbranch_scc1 K_svc
    v_lshrrev_b32 v12, 5, v0
    v_and_b32 v8, 31, v0
    v_lshlrev_b32 v7, 4, v8
    v_lshl_add_u32 v7, v12, 13, v7
    s_lshl_b32 s57, s52, 9
    s_lshl_b32 s61, s55, 11
    s_add_u32 s57, s57, s61
    s_add_u32 s43, s57, 81920
    s_lshl_b32 s61, s53, 14
    s_add_u32 s57, s57, s61
    s_mul_i32 s69, s55, 4160
    s_add_u32 s69, s69, 80640
    s_mov_b32 m0, s69
    v_and_b32 v11, 15, v0
    v_bfe_u32 v13, v0, 4, 1
    v_mul_u32_u24 v14, 1040, v11
    v_lshl_add_u32 v14, v13, 9, v14
    v_lshl_add_u32 v14, v12, 4, v14
    v_add_u32 v6, 80640, v14
    v_bfe_u32 v14, v0, 2, 1
    v_lshl_add_u32 v14, v12, 1, v14
    v_and_b32 v16, 8, v0
    v_add_u32 v14, v14, v16
    v_lshl_add_u32 v14, v13, 5, v14
    v_bfe_u32 v16, v0, 3, 2
    v_xor_b32 v16, s55, v16
    v_and_b32 v17, 3, v0
    v_lshlrev_b32 v17, 3, v17
    v_lshl_add_u32 v17, v16, 5, v17
    v_add_u32 v17, 15104, v17
    v_lshl_add_u32 v3, v14, 7, v17
    v_mov_b32 v5, 1
    s_cmp_eq_u32 s54, 1
    s_cbranch_scc0 K_qr
    s_mov_b32 s44, 0x33333333
    s_mov_b32 s46, 0x55555555
    s_mov_b32 s45, s44
    s_mov_b32 s47, s46
    v_and_b32 v10, 28, v0
    v_lshl_add_u32 v10, v12, 1, v10
    v_lshlrev_b32 v10, 8, v10
    v_and_b32 v14, 3, v0
    v_lshl_add_u32 v10, v14, 4, v10
    s_mul_i32 s71, s53, 2623488
    s_lshl_b32 s61, s52, 8
    s_add_u32 s71, s71, s61
    s_lshl_b32 s61, s55, 6
    s_add_u32 s71, s71, s61
    s_mov_b32 s42, s71
    s_add_u32 s43, s71, 40960
    s_lshl_b32 s61, s53, 13
    s_add_u32 s71, s71, s61
    s_lshl_b32 s65, s53, 6
    s_add_u32 s65, s65, s100
    s_lshl_b32 s65, s65, 7
    s_add_u32 s65, s65, 21069824
    s_mov_b32 s68, 0xbfb8aa3b
    s_mov_b32 s70, 1
    v_mov_b32 v1, 0x100001
    v_mov_b32 v11, 1
    s_mov_b32 s56, 6
    s_bitcmp1_b32 s55, 0
    s_waitcnt lgkmcnt(0)
    s_mov_b64 s[28:29], s[4:5]
    s_cselect_b64 s[36:37], s[20:21], s[14:15]
    buffer_load_dwordx4 v7, s[28:31], s57 offen offset:0  lds
    s_add_u32 m0, m0, 528
    s_nop 0
    buffer_load_dwordx4 v7, s[28:31], s57 offen offset:512  lds
    s_add_u32 m0, m0, 528
    s_nop 0
    buffer_load_dwordx4 v7, s[28:31], s57 offen offset:1024  lds
    s_add_u32 m0, m0, 528
    s_nop 0
    buffer_load_dwordx4 v7, s[28:31], s57 offen offset:1536  lds
    s_and_b32 s66, s66, 7
    s_lshl_b32 s59, s66, 14
    s_lshl_b32 s61, s66, 13
    s_add_u32 m0, s61, s64
    s_add_u32 s59, s59, s63
    buffer_load_dwordx4 v2, s[36:39], s59 offen offset:0  lds
    buffer_load_dwordx4 v15, s[36:39], s59 offen offset:1024  lds
    buffer_load_dwordx4 v2, s[36:39], s59 offen offset:2048  lds
    buffer_load_dwordx4 v15, s[36:39], s59 offen offset:3072  lds
    s_barrier
    s_mov_b64 s[32:33], s[26:27]
    s_waitcnt vmcnt(0)
    s_mov_b64 exec, 1
    ds_add_u32 v4, v1 offset:0
    s_mov_b64 exec, -1
sp1:
    ds_read_b32 v12, v4 offset:0
    s_sub_u32 s60, s60, 1
    s_cbranch_scc1 K_exit
    s_waitcnt lgkmcnt(0)
    v_readfirstlane_b32 s61, v12
    s_bitcmp1_b32 s61, 24
    s_cbranch_scc0 sp1
    ds_read_b64_tr_b16 v[64:65], v3 offset:0
    ds_read_b64_tr_b16 v[66:67], v3 offset:2048
    ds_read_b64_tr_b16 v[68:69], v3 offset:512
    ds_read_b64_tr_b16 v[70:71], v3 offset:2560
    ds_read_b128 v[32:35], v6 offset:0
    ds_read_b128 v[36:39], v6 offset:32
    ds_read_b64_tr_b16 v[72:73], v3 offset:8192
    ds_read_b64_tr_b16 v[74:75], v3 offset:10240
    ds_read_b64_tr_b16 v[76:77], v3 offset:8704
    ds_read_b64_tr_b16 v[78:79], v3 offset:10752
    ds_read_b64_tr_b16 v[80:81], v3 offset:16384
    ds_read_b64_tr_b16 v[82:83], v3 offset:18432
    ds_read_b64_tr_b16 v[84:85], v3 offset:16896
    ds_read_b64_tr_b16 v[86:87], v3 offset:18944
    ds_read_b64_tr_b16 v[88:89], v3 offset:24576
    ds_read_b64_tr_b16 v[90:91], v3 offset:26624
    ds_read_b64_tr_b16 v[92:93], v3 offset:25088
    ds_read_b64_tr_b16 v[94:95], v3 offset:27136
    ds_read_b64_tr_b16 v[96:97], v3 offset:32768
    ds_read_b64_tr_b16 v[98:99], v3 offset:34816
    ds_read_b64_tr_b16 v[100:101], v3 offset:33280
    ds_read_b64_tr_b16 v[102:103], v3 offset:35328
    ds_read_b64_tr_b16 v[104:105], v3 offset:40960
    ds_read_b64_tr_b16 v[106:107], v3 offset:43008
    ds_read_b64_tr_b16 v[108:109], v3 offset:41472
    ds_read_b64_tr_b16 v[110:111], v3 offset:43520
    ds_read_b64_tr_b16 v[112:113], v3 offset:49152
    ds_read_b64_tr_b16 v[114:115], v3 offset:51200
    ds_read_b64_tr_b16 v[116:117], v3 offset:49664
    ds_read_b64_tr_b16 v[118:119], v3 offset:51712
    ds_read_b64_tr_b16 v[120:121], v3 offset:57344
    ds_read_b64_tr_b16 v[122:123], v3 offset:59392
    ds_read_b64_tr_b16 v[124:125], v3 offset:57856
    ds_read_b64_tr_b16 v[126:127], v3 offset:59904
    s_mov_b64 exec, 1
    s_branch K_padA0s
K_padA0:
    s_setpc_b64 s[70:71]
K_padA0s:
    ds_add_u32 v4, v5 offset:4
    s_mov_b64 exec, -1
    ds_read_b128 v[40:43], v6 offset:64
    ds_read_b128 v[44:47], v6 offset:96
    ds_read_b128 v[48:51], v6 offset:128
    ds_read_b128 v[52:55], v6 offset:160
    ds_read_b128 v[56:59], v6 offset:192
    ds_read_b128 v[60:63], v6 offset:224
P_loop:
    s_waitcnt lgkmcnt(6)
    v_mfma_f32_32x32x16_bf16 v[16:31], v[64:67], v[32:35], 0
    ds_read_b128 v[32:35], v6 offset:256
    v_mfma_f32_32x32x16_bf16 v[16:31], v[68:71], v[36:39], v[16:31]
    ds_read_b128 v[36:39], v6 offset:288
    s_cmp_lt_u32 s56, 22
    s_cselect_b32 s59, 16640, 0
    s_waitcnt lgkmcnt(6)
    v_mfma_f32_32x32x16_bf16 v[16:31], v[72:75], v[40:43], v[16:31]
    ds_read_b128 v[40:43], v6 offset:320
    v_mfma_f32_32x32x16_bf16 v[16:31], v[76:79], v[44:47], v[16:31]
    ds_read_b128 v[44:47], v6 offset:352
    s_waitcnt lgkmcnt(6)
    v_mfma_f32_32x32x16_bf16 v[16:31], v[80:83], v[48:51], v[16:31]
    ds_read_b128 v[48:51], v6 offset:384
    v_mfma_f32_32x32x16_bf16 v[16:31], v[84:87], v[52:55], v[16:31]
    ds_read_b128 v[52:55], v6 offset:416
    s_waitcnt lgkmcnt(6)
    v_mfma_f32_32x32x16_bf16 v[16:31], v[88:91], v[56:59], v[16:31]
    ds_read_b128 v[56:59], v6 offset:448
    v_mfma_f32_32x32x16_bf16 v[16:31], v[92:95], v[60:63], v[16:31]
    ds_read_b32 v12, v4 offset:0
    ds_read_b128 v[60:63], v6 offset:480
    v_add_u32 v6, s59, v6
    s_mov_b64 exec, 1
    ds_add_u32 v4, v11 offset:20
    s_mov_b64 exec, -1
    s_waitcnt lgkmcnt(6)
    v_mfma_f32_32x32x16_bf16 v[16:31], v[96:99], v[32:35], v[16:31]
    ds_read_b128 v[32:35], v6 offset:0
    v_lshlrev_b32 v11, 4, v11
    v_mfma_f32_32x32x16_bf16 v[16:31], v[100:103], v[36:39], v[16:31]
    ds_read_b128 v[36:39], v6 offset:32
    s_waitcnt lgkmcnt(6)
    v_mfma_f32_32x32x16_bf16 v[16:31], v[104:107], v[40:43], v[16:31]
    ds_read_b128 v[40:43], v6 offset:64
    v_mfma_f32_32x32x16_bf16 v[16:31], v[108:111], v[44:47], v[16:31]
    ds_read_b128 v[44:47], v6 offset:96
    s_waitcnt lgkmcnt(6)
    v_mfma_f32_32x32x16_bf16 v[16:31], v[112:115], v[48:51], v[16:31]
    ds_read_b128 v[48:51], v6 offset:128
    v_mfma_f32_32x32x16_bf16 v[16:31], v[116:119], v[52:55], v[16:31]
    ds_read_b128 v[52:55], v6 offset:160
    s_waitcnt lgkmcnt(6)
    v_mfma_f32_32x32x16_bf16 v[16:31], v[120:123], v[56:59], v[16:31]
    ds_read_b128 v[56:59], v6 offset:192
    v_readfirstlane_b32 s67, v12
    v_mfma_f32_32x32x16_bf16 v[16:31], v[124:127], v[60:63], v[16:31]
    ds_read_b128 v[60:63], v6 offset:224
    s_nop 10
    v_mul_f32 v16, s68, v16
    v_mul_f32 v17, s68, v17
    v_mul_f32 v18, s68, v18
    v_mul_f32 v19, s68, v19
    v_mul_f32 v20, s68, v20
    v_mul_f32 v21, s68, v21
    v_mul_f32 v22, s68, v22
    v_mul_f32 v23, s68, v23
    v_max3_f32 v12, abs(v16), abs(v17), abs(v18)
    v_max3_f32 v13, abs(v19), abs(v20), abs(v21)
    v_max3_f32 v12, abs(v22), abs(v23), v12
    v_max_f32 v12, v12, v13
    v_cmp_nge_f32 vcc, 0x41e00000, v12
    s_nop 1
    s_cbranch_vccnz P_raw
    v_exp_f32 v16, v16
    v_exp_f32 v17, v17
    v_exp_f32 v18, v18
    v_exp_f32 v19, v19
    v_exp_f32 v20, v20
    v_exp_f32 v21, v21
    v_exp_f32 v22, v22
    v_exp_f32 v23, v23
    v_cvt_pk_bf16_f32 v16, v24, v16
    v_cvt_pk_bf16_f32 v17, v25, v17
    v_cvt_pk_bf16_f32 v18, v26, v18
    v_cvt_pk_bf16_f32 v19, v27, v19
    v_cvt_pk_bf16_f32 v20, v28, v20
    v_cvt_pk_bf16_f32 v21, v29, v21
    v_cvt_pk_bf16_f32 v22, v30, v22
    v_cvt_pk_bf16_f32 v23, v31, v23
P_rawr:
    s_mov_b64 vcc, s[44:45]
    v_cndmask_b32_dpp v24, v20, v16, vcc quad_perm:[2,3,0,1] row_mask:0xf bank_mask:0xf
    v_cndmask_b32_dpp v25, v21, v17, vcc quad_perm:[2,3,0,1] row_mask:0xf bank_mask:0xf
    v_cndmask_b32_dpp v26, v22, v18, vcc quad_perm:[2,3,0,1] row_mask:0xf bank_mask:0xf
    v_cndmask_b32_dpp v27, v23, v19, vcc quad_perm:[2,3,0,1] row_mask:0xf bank_mask:0xf
    s_not_b64 vcc, vcc
    v_cndmask_b32_dpp v28, v16, v20, vcc quad_perm:[2,3,0,1] row_mask:0xf bank_mask:0xf
    v_cndmask_b32_dpp v29, v17, v21, vcc quad_perm:[2,3,0,1] row_mask:0xf bank_mask:0xf
    v_cndmask_b32_dpp v30, v18, v22, vcc quad_perm:[2,3,0,1] row_mask:0xf bank_mask:0xf
    v_cndmask_b32_dpp v31, v19, v23, vcc quad_perm:[2,3,0,1] row_mask:0xf bank_mask:0xf
    v_permlane32_swap_b32 v24, v28
    v_permlane32_swap_b32 v25, v29
    v_permlane32_swap_b32 v26, v30
    v_permlane32_swap_b32 v27, v31
    s_mov_b64 vcc, s[46:47]
    v_cndmask_b32_dpp v16, v28, v24, vcc quad_perm:[1,0,3,2] row_mask:0xf bank_mask:0xf
    v_cndmask_b32_dpp v17, v29, v25, vcc quad_perm:[1,0,3,2] row_mask:0xf bank_mask:0xf
    v_cndmask_b32_dpp v18, v30, v26, vcc quad_perm:[1,0,3,2] row_mask:0xf bank_mask:0xf
    v_cndmask_b32_dpp v19, v31, v27, vcc quad_perm:[1,0,3,2] row_mask:0xf bank_mask:0xf
    s_not_b64 vcc, vcc
    v_cndmask_b32_dpp v20, v24, v28, vcc quad_perm:[1,0,3,2] row_mask:0xf bank_mask:0xf
    v_cndmask_b32_dpp v21, v25, v29, vcc quad_perm:[1,0,3,2] row_mask:0xf bank_mask:0xf
    v_cndmask_b32_dpp v22, v26, v30, vcc quad_perm:[1,0,3,2] row_mask:0xf bank_mask:0xf
    v_cndmask_b32_dpp v23, v27, v31, vcc quad_perm:[1,0,3,2] row_mask:0xf bank_mask:0xf
    buffer_store_dwordx4 v[16:19], v10, s[32:35], s71 offen sc1
    buffer_store_dwordx4 v[20:23], v10, s[32:35], s71 offen offset:256 sc1
P_sk:
    s_add_u32 s71, s71, 8192
    s_cmp_eq_u32 s71, s43
    s_cselect_b32 s71, s42, s71
    s_bitcmp1_b32 s67, s56
    s_cbranch_scc0 P_xw
    s_add_u32 s56, s56, 4
    s_branch P_loop
P_xw:
    s_cmp_eq_u32 s56, 22
    s_cbranch_scc1 P_done
sp2:
    ds_read_b32 v12, v4 offset:0
    s_sub_u32 s60, s60, 1
    s_cbranch_scc1 K_exit
    s_waitcnt lgkmcnt(0)
    v_readfirstlane_b32 s61, v12
    s_bitcmp1_b32 s61, s56
    s_cbranch_scc0 sp2
    ds_read_b128 v[32:35], v6 offset:0
    ds_read_b128 v[36:39], v6 offset:32
    ds_read_b128 v[40:43], v6 offset:64
    ds_read_b128 v[44:47], v6 offset:96
    ds_read_b128 v[48:51], v6 offset:128
    ds_read_b128 v[52:55], v6 offset:160
    ds_read_b128 v[56:59], v6 offset:192
    ds_read_b128 v[60:63], v6 offset:224
    s_add_u32 s56, s56, 4
    s_branch P_loop
P_done:
    s_setprio 3
    v_and_b32 v11, 15, v0
    v_lshlrev_b32 v11, 4, v11
sp3:
    ds_read_b32 v12, v4 offset:28
    s_sub_u32 s60, s60, 1
    s_cbranch_scc1 K_exit
    s_waitcnt lgkmcnt(0)
    v_readfirstlane_b32 s61, v12
    s_cmp_lg_u32 s61, 0
    s_cbranch_scc0 sp3
    ds_read_b128 v[32:35], v11 offset:2064
    s_lshl_b32 s61, s55, 2
    v_lshrrev_b32 v12, 4, v0
    v_add_u32 v12, s61, v12
    v_cvt_f32_u32 v41, v12
    v_mov_b32 v13, 0xc5800000
    v_fmamk_f32 v40, v41, 0x43000000, v13
    v_mov_b32 v42, 0x45000000
    v_mov_b32 v43, 0x41800000
    s_lshl_b32 s61, s55, 10
    s_add_u32 s61, s61, 15104
    v_lshl_add_u32 v11, v0, 4, s61
    v_mov_b32 v1, s70
    s_waitcnt lgkmcnt(0)
P_arr:
    s_setprio 3
    s_waitcnt vmcnt(0)
    s_mov_b64 exec, 1
    ds_add_rtn_u32 v12, v4, v1 offset:16
    s_waitcnt lgkmcnt(0)
    v_add_u32 v12, v12, v1
    v_cmpx_eq_u16 vcc, 4, v12
    buffer_store_dword v12, v4, s[32:35], s65 offen sc1
    s_cbranch_execz P_npf
    s_mov_b64 exec, -1
    v_lshlrev_b32 v13, 7, v0
    s_andn2_b32 s71, s43, 255
    s_branch K_padB0s
K_padB0:
    s_branch K_padC0
K_padB0s:
    s_sub_u32 s71, s71, 8192
    buffer_load_dword v28, v13, s[32:35], s71 offen sc1
    s_sub_u32 s71, s71, 8192
    buffer_load_dword v28, v13, s[32:35], s71 offen sc1
    s_sub_u32 s71, s71, 8192
    buffer_load_dword v28, v13, s[32:35], s71 offen sc1
    s_sub_u32 s71, s71, 8192
    buffer_load_dword v28, v13, s[32:35], s71 offen sc1
    s_sub_u32 s71, s71, 8192
    buffer_load_dword v28, v13, s[32:35], s71 offen sc1
P_npf:
    s_mov_b64 exec, -1
    s_setprio 3
    v_pk_mul_f32 v[64:65], v[32:33], v[40:41] op_sel_hi:[1,0]
    v_pk_mul_f32 v[66:67], v[34:35], v[40:41] op_sel_hi:[1,0]
    v_pk_mul_f32 v[96:97], v[32:33], v[40:41] op_sel:[0,1] op_sel_hi:[1,1]
    v_pk_mul_f32 v[98:99], v[34:35], v[40:41] op_sel:[0,1] op_sel_hi:[1,1]
    v_pk_mul_f32 v[44:45], v[32:33], v[42:43] op_sel_hi:[1,0]
    v_pk_mul_f32 v[46:47], v[34:35], v[42:43] op_sel_hi:[1,0]
    v_pk_mul_f32 v[48:49], v[32:33], v[42:43] op_sel:[0,1] op_sel_hi:[1,1]
    v_pk_mul_f32 v[50:51], v[34:35], v[42:43] op_sel:[0,1] op_sel_hi:[1,1]
    v_exp_f32 v44, v44
    v_exp_f32 v45, v45
    v_exp_f32 v46, v46
    v_exp_f32 v47, v47
    v_exp_f32 v48, v48
    v_exp_f32 v49, v49
    v_exp_f32 v50, v50
    v_exp_f32 v51, v51
    v_exp_f32 v64, v64
    v_exp_f32 v65, v65
    v_exp_f32 v66, v66
    v_exp_f32 v67, v67
    v_exp_f32 v96, v96
    v_exp_f32 v97, v97
    v_exp_f32 v98, v98
    v_exp_f32 v99, v99
    v_pk_mul_f32 v[52:53], v[44:45], v[44:45]
    v_pk_mul_f32 v[54:55], v[46:47], v[46:47]
    v_pk_mul_f32 v[56:57], v[48:49], v[48:49]
    v_pk_mul_f32 v[58:59], v[50:51], v[50:51]
    v_pk_mul_f32 v[68:69], v[64:65], v[44:45]
    v_pk_mul_f32 v[70:71], v[66:67], v[46:47]
    v_pk_mul_f32 v[100:101], v[96:97], v[48:49]
    v_pk_mul_f32 v[102:103], v[98:99], v[50:51]
    v_pk_mul_f32 v[48:49], v[56:57], v[56:57]
    v_pk_mul_f32 v[50:51], v[58:59], v[58:59]
    v_pk_mul_f32 v[72:73], v[64:65], v[52:53]
    v_pk_mul_f32 v[74:75], v[66:67], v[54:55]
    v_pk_mul_f32 v[76:77], v[68:69], v[52:53]
    v_pk_mul_f32 v[78:79], v[70:71], v[54:55]
    v_pk_mul_f32 v[104:105], v[96:97], v[56:57]
    v_pk_mul_f32 v[106:107], v[98:99], v[58:59]
    v_pk_mul_f32 v[108:109], v[100:101], v[56:57]
    v_pk_mul_f32 v[110:111], v[102:103], v[58:59]
    v_pk_mul_f32 v[112:113], v[96:97], v[48:49]
    v_pk_mul_f32 v[114:115], v[98:99], v[50:51]
    v_pk_mul_f32 v[116:117], v[100:101], v[48:49]
    v_pk_mul_f32 v[118:119], v[102:103], v[50:51]
    v_pk_mul_f32 v[120:121], v[104:105], v[48:49]
    v_pk_mul_f32 v[122:123], v[106:107], v[50:51]
    v_pk_mul_f32 v[124:125], v[108:109], v[48:49]
    v_pk_mul_f32 v[126:127], v[110:111], v[50:51]
sp4:
    ds_read_b32 v12, v4 offset:12
    s_sub_u32 s60, s60, 1
    s_cbranch_scc1 K_exit
    s_waitcnt lgkmcnt(0)
    v_readfirstlane_b32 s61, v12
    s_bitcmp1_b32 s61, 3
    s_cbranch_scc1 sp4d
    s_sleep 1
    s_branch sp4
sp4d:
    v_mov_b32 v1, 2
    ds_write_b128 v11, v[64:67] offset:16384
    ds_write_b128 v11, v[68:71] offset:20480
    ds_write_b128 v11, v[72:75] offset:24576
    ds_write_b128 v11, v[76:79] offset:28672
    ds_write_b128 v11, v[96:99] offset:32768
    ds_write_b128 v11, v[100:103] offset:36864
    ds_write_b128 v11, v[104:107] offset:40960
    ds_write_b128 v11, v[108:111] offset:45056
    ds_write_b128 v11, v[112:115] offset:49152
    ds_write_b128 v11, v[116:119] offset:53248
    ds_write_b128 v11, v[120:123] offset:57344
    ds_write_b128 v11, v[124:127] offset:61440
    s_mov_b64 exec, 1
    ds_add_u32 v4, v1 offset:24
    s_mov_b64 exec, -1
    s_setprio 3
    s_cmp_eq_u32 s55, 0
    s_cbranch_scc1 K_fin
    s_branch K_setup
K_fin:
    s_lshl_b32 s64, s53, 13
    s_add_u32 s64, s64, 21069824
    v_lshlrev_b32 v1, 7, v0
    s_mov_b64 s[66:67], 0
K_finp:
    buffer_load_dword v3, v1, s[32:35], s64 offen sc1
    s_sub_u32 s62, s62, 1
    s_cbranch_scc1 K_finto
    s_waitcnt vmcnt(0)
    v_cmp_lt_u32 vcc, 15, v3
    s_or_b64 s[66:67], s[66:67], vcc
    v_cmpx_eq_u32 vcc, 0, v3
    s_cbranch_execnz K_finp
K_fino:
    s_cmp_lg_u64 s[66:67], 0
    s_cselect_b32 s61, 65536, 0
    s_bitset1_b32 s61, 13
    s_mov_b64 exec, 1
    v_mov_b32 v1, s61
    s_mov_b64 exec, 1
    ds_add_u32 v4, v1 offset:24
    s_mov_b64 exec, -1
    s_waitcnt vmcnt(0)
    s_branch K_setup
.fill 96, 4, 0xbf800000
K_qr:
    s_barrier
    s_andn2_b32 s61, 256, s63
    s_lshl_b32 s59, s55, 6
    s_add_u32 s61, s61, s59
    v_add_u32 v10, s61, v6
    s_mov_b32 s68, 0x3fb8aa3b
    s_mov_b32 s70, 1
    s_cmp_eq_u32 s54, 2
    s_cbranch_scc0 K_r
    v_mov_b32 v1, 0x200000
    v_mov_b32 v11, 1
    s_mov_b32 s56, 10
    s_mov_b32 s58, 3
    s_bitcmp1_b32 s55, 0
    s_waitcnt lgkmcnt(0)
    s_cselect_b64 s[36:37], s[20:21], s[14:15]
    s_cselect_b64 s[40:41], s[18:19], s[12:13]
    s_and_b32 s66, s66, 7
    s_lshl_b32 s59, s66, 14
    s_lshl_b32 s61, s66, 13
    s_add_u32 m0, s61, s64
    s_add_u32 s59, s59, s63
    buffer_load_dwordx4 v2, s[36:39], s59 offen offset:0  lds
    buffer_load_dwordx4 v15, s[36:39], s59 offen offset:1024  lds
    buffer_load_dwordx4 v2, s[36:39], s59 offen offset:2048  lds
    buffer_load_dwordx4 v15, s[36:39], s59 offen offset:3072  lds
    s_add_u32 s66, s66, 2
    s_and_b32 s66, s66, 7
    s_lshl_b32 s59, s66, 14
    s_lshl_b32 s61, s66, 13
    s_add_u32 m0, s61, s64
    s_add_u32 s59, s59, s63
    buffer_load_dwordx4 v2, s[36:39], s59 offen offset:0  lds
    buffer_load_dwordx4 v15, s[36:39], s59 offen offset:1024  lds
    buffer_load_dwordx4 v2, s[36:39], s59 offen offset:2048  lds
    buffer_load_dwordx4 v15, s[36:39], s59 offen offset:3072  lds
    s_mov_b64 s[36:37], s[40:41]
    s_lshr_b32 s42, s2, 3
    s_lshl_b32 s42, s42, 12
    s_add_u32 s42, s42, s63
    v_lshrrev_b32 v16, 3, v0
    v_and_b32 v17, 7, v0
    v_lshlrev_b32 v17, 4, v17
    v_lshl_add_u32 v16, v16, 9, v17
    s_lshl_b32 s61, s55, 15
    s_and_b32 s61, s61, 0x10000
    s_xor_b32 s42, s42, s61
    buffer_load_dwordx4 v[20:23], v16, s[36:39], s42 offen
    s_waitcnt vmcnt(1)
    s_mov_b64 exec, 1
    ds_add_u32 v4, v1 offset:0
    s_mov_b64 exec, -1
    s_mov_b64 s[36:37], s[40:41]
    s_setprio 2
sp5:
    ds_read_b32 v12, v4 offset:4
    s_sub_u32 s60, s60, 1
    s_cbranch_scc1 K_exit
    s_waitcnt lgkmcnt(0)
    v_readfirstlane_b32 s61, v12
    s_cmp_eq_u32 s61, 4
    s_cbranch_scc1 sp5d
    s_sleep 1
    s_branch sp5
sp5d:
    s_add_u32 s66, s66, 2
    s_and_b32 s66, s66, 7
    s_lshl_b32 s59, s66, 14
    s_lshl_b32 s61, s66, 13
    s_add_u32 m0, s61, s64
    s_add_u32 s59, s59, s63
    buffer_load_dwordx4 v2, s[36:39], s59 offen offset:0  lds
    buffer_load_dwordx4 v15, s[36:39], s59 offen offset:1024  lds
    buffer_load_dwordx4 v2, s[36:39], s59 offen offset:2048  lds
    buffer_load_dwordx4 v15, s[36:39], s59 offen offset:3072  lds
    s_mov_b64 exec, 1
    ds_add_u32 v4, v5 offset:40
    s_mov_b64 exec, -1
    s_add_u32 s66, s66, 2
    s_and_b32 s66, s66, 7
    s_lshl_b32 s59, s66, 14
    s_lshl_b32 s61, s66, 13
    s_add_u32 m0, s61, s64
    s_add_u32 s59, s59, s63
    buffer_load_dwordx4 v2, s[36:39], s59 offen offset:0  lds
    buffer_load_dwordx4 v15, s[36:39], s59 offen offset:1024  lds
    buffer_load_dwordx4 v2, s[36:39], s59 offen offset:2048  lds
    buffer_load_dwordx4 v15, s[36:39], s59 offen offset:3072  lds
    s_mov_b64 exec, 1
    ds_add_u32 v4, v5 offset:40
    s_mov_b64 exec, -1
    s_add_u32 s66, s66, 2
    s_and_b32 s66, s66, 7
    s_lshl_b32 s59, s66, 14
    s_lshl_b32 s61, s66, 13
    s_add_u32 m0, s61, s64
    s_add_u32 s59, s59, s63
    buffer_load_dwordx4 v2, s[36:39], s59 offen offset:0  lds
    buffer_load_dwordx4 v15, s[36:39], s59 offen offset:1024  lds
    buffer_load_dwordx4 v2, s[36:39], s59 offen offset:2048  lds
    buffer_load_dwordx4 v15, s[36:39], s59 offen offset:3072  lds
    s_mov_b64 exec, 1
    ds_add_u32 v4, v5 offset:40
    s_mov_b64 exec, -1
    s_add_u32 s66, s66, 2
    s_and_b32 s66, s66, 7
    s_lshl_b32 s59, s66, 14
    s_lshl_b32 s61, s66, 13
    s_add_u32 m0, s61, s64
    s_add_u32 s59, s59, s63
    buffer_load_dwordx4 v2, s[36:39], s59 offen offset:0  lds
    buffer_load_dwordx4 v15, s[36:39], s59 offen offset:1024  lds
    buffer_load_dwordx4 v2, s[36:39], s59 offen offset:2048  lds
    buffer_load_dwordx4 v15, s[36:39], s59 offen offset:3072  lds
    s_mov_b64 exec, 1
    ds_add_u32 v4, v5 offset:40
    s_mov_b64 exec, -1
    s_waitcnt vmcnt(0)
    s_mov_b64 exec, 1
    ds_add_u32 v4, v5 offset:8
    s_mov_b64 exec, -1
    v_mov_b32 v1, 0
    s_branch K_au
K_r:
    s_setprio 1
    v_add_u32 v6, 16640, v6
    v_add_u32 v10, 16640, v10
    v_mov_b32 v11, 0x10
    v_mov_b32 v1, 0x10
    s_mov_b32 s56, 14
    s_mov_b32 s58, 7
    s_waitcnt lgkmcnt(0)
    s_mov_b64 s[28:29], s[4:5]
    s_add_u32 m0, s69, 16640
    s_add_u32 s57, s57, 16384
    s_cmp_ge_u32 s57, s43
    s_cselect_b32 s61, 81920, 0
    s_sub_u32 s57, s57, s61
    buffer_load_dwordx4 v7, s[28:31], s57 offen offset:0  lds
    s_add_u32 m0, m0, 528
    s_nop 0
    buffer_load_dwordx4 v7, s[28:31], s57 offen offset:512  lds
    s_add_u32 m0, m0, 528
    s_nop 0
    buffer_load_dwordx4 v7, s[28:31], s57 offen offset:1024  lds
    s_add_u32 m0, m0, 528
    s_nop 0
    buffer_load_dwordx4 v7, s[28:31], s57 offen offset:1536  lds
    s_add_u32 m0, s69, 33280
    s_add_u32 s57, s57, 16384
    s_cmp_ge_u32 s57, s43
    s_cselect_b32 s61, 81920, 0
    s_sub_u32 s57, s57, s61
    buffer_load_dwordx4 v7, s[28:31], s57 offen offset:0  lds
    s_add_u32 m0, m0, 528
    s_nop 0
    s_branch K_padA2s
K_padA2:
    s_setpc_b64 s[70:71]
K_padA2s:
    buffer_load_dwordx4 v7, s[28:31], s57 offen offset:512  lds
    s_add_u32 m0, m0, 528
    s_nop 0
    buffer_load_dwordx4 v7, s[28:31], s57 offen offset:1024  lds
    s_add_u32 m0, m0, 528
    s_nop 0
    buffer_load_dwordx4 v7, s[28:31], s57 offen offset:1536  lds
    s_waitcnt vmcnt(4)
    s_mov_b64 exec, 1
    ds_add_u32 v4, v1 offset:0
    s_mov_b64 exec, -1
    v_lshlrev_b32 v1, 4, v1
    s_waitcnt vmcnt(0)
    s_mov_b64 exec, 1
    ds_add_u32 v4, v1 offset:0
    s_mov_b64 exec, -1
    v_lshlrev_b32 v1, 4, v1
K_au:
    s_mov_b64 s[32:33], s[26:27]
sp6:
    ds_read_b32 v12, v4 offset:8
    s_sub_u32 s60, s60, 1
    s_cbranch_scc1 K_exit
    s_waitcnt lgkmcnt(0)
    v_readfirstlane_b32 s61, v12
    s_cmp_eq_u32 s61, 4
    s_cbranch_scc1 sp6d
    s_sleep 1
    s_branch sp6
sp6d:
    s_setprio 2
    ds_read_b64_tr_b16 v[64:65], v3 offset:0
    ds_read_b64_tr_b16 v[66:67], v3 offset:2048
    ds_read_b64_tr_b16 v[68:69], v3 offset:512
    ds_read_b64_tr_b16 v[70:71], v3 offset:2560
    ds_read_b64_tr_b16 v[72:73], v3 offset:8192
    ds_read_b64_tr_b16 v[74:75], v3 offset:10240
    ds_read_b64_tr_b16 v[76:77], v3 offset:8704
    ds_read_b64_tr_b16 v[78:79], v3 offset:10752
    ds_read_b64_tr_b16 v[80:81], v3 offset:16384
    ds_read_b64_tr_b16 v[82:83], v3 offset:18432
    ds_read_b64_tr_b16 v[84:85], v3 offset:16896
    ds_read_b64_tr_b16 v[86:87], v3 offset:18944
    ds_read_b64_tr_b16 v[88:89], v3 offset:24576
    ds_read_b64_tr_b16 v[90:91], v3 offset:26624
    ds_read_b64_tr_b16 v[92:93], v3 offset:25088
    ds_read_b64_tr_b16 v[94:95], v3 offset:27136
    ds_read_b64_tr_b16 v[96:97], v3 offset:32768
    ds_read_b64_tr_b16 v[98:99], v3 offset:34816
    ds_read_b64_tr_b16 v[100:101], v3 offset:33280
    ds_read_b64_tr_b16 v[102:103], v3 offset:35328
    ds_read_b64_tr_b16 v[104:105], v3 offset:40960
    ds_read_b64_tr_b16 v[106:107], v3 offset:43008
    ds_read_b64_tr_b16 v[108:109], v3 offset:41472
    ds_read_b64_tr_b16 v[110:111], v3 offset:43520
    ds_read_b64_tr_b16 v[112:113], v3 offset:49152
    ds_read_b64_tr_b16 v[114:115], v3 offset:51200
    ds_read_b64_tr_b16 v[116:117], v3 offset:49664
    ds_read_b64_tr_b16 v[118:119], v3 offset:51712
    ds_read_b64_tr_b16 v[120:121], v3 offset:57344
    ds_read_b64_tr_b16 v[122:123], v3 offset:59392
    ds_read_b64_tr_b16 v[124:125], v3 offset:57856
    ds_read_b64_tr_b16 v[126:127], v3 offset:59904
    s_mov_b64 exec, 1
    ds_add_u32 v4, v5 offset:12
    s_mov_b64 exec, -1
    s_sub_u32 s59, s56, 8
sp7:
    ds_read_b32 v12, v4 offset:0
    s_sub_u32 s60, s60, 1
    s_cbranch_scc1 K_exit
    s_waitcnt lgkmcnt(0)
    v_readfirstlane_b32 s61, v12
    s_bitcmp1_b32 s61, s59
    s_cbranch_scc0 sp7
    ds_read_b128 v[32:35], v6 offset:0
    ds_read_b128 v[36:39], v6 offset:32
    ds_read_b128 v[40:43], v6 offset:64
    ds_read_b128 v[44:47], v6 offset:96
    ds_read_b128 v[48:51], v6 offset:128
    ds_read_b128 v[52:55], v6 offset:160
    ds_read_b128 v[56:59], v6 offset:192
    ds_read_b128 v[60:63], v6 offset:224
.fill 14, 4, 0xbf800000
U_loop:
    s_waitcnt lgkmcnt(6)
    v_mfma_f32_32x32x16_bf16 v[16:31], v[64:67], v[32:35], 0
    ds_read_b128 v[32:35], v6 offset:256
    v_mfma_f32_32x32x16_bf16 v[16:31], v[68:71], v[36:39], v[16:31]
    ds_read_b128 v[36:39], v6 offset:288
    s_cmp_lt_u32 s56, 22
    s_cselect_b32 s59, 33280, 0
    s_waitcnt lgkmcnt(6)
    v_mfma_f32_32x32x16_bf16 v[16:31], v[72:75], v[40:43], v[16:31]
    ds_read_b128 v[40:43], v6 offset:320
    v_mfma_f32_32x32x16_bf16 v[16:31], v[76:79], v[44:47], v[16:31]
    ds_read_b128 v[44:47], v6 offset:352
    s_waitcnt lgkmcnt(6)
    v_mfma_f32_32x32x16_bf16 v[16:31], v[80:83], v[48:51], v[16:31]
    ds_read_b128 v[48:51], v6 offset:384
    v_mfma_f32_32x32x16_bf16 v[16:31], v[84:87], v[52:55], v[16:31]
    ds_read_b128 v[52:55], v6 offset:416
    s_waitcnt lgkmcnt(6)
    v_mfma_f32_32x32x16_bf16 v[16:31], v[88:91], v[56:59], v[16:31]
    ds_read_b128 v[56:59], v6 offset:448
    v_mfma_f32_32x32x16_bf16 v[16:31], v[92:95], v[60:63], v[16:31]
    ds_read_b32 v12, v4 offset:20
    ds_read_b128 v[60:63], v6 offset:480
    v_add_u32 v6, s59, v6
    s_mov_b64 exec, 1
    ds_add_u32 v4, v11 offset:20
    s_mov_b64 exec, -1
    s_waitcnt lgkmcnt(6)
    v_mfma_f32_32x32x16_bf16 v[16:31], v[96:99], v[32:35], v[16:31]
    ds_read_b128 v[32:35], v6 offset:0
    v_lshlrev_b32 v11, 8, v11
    v_mfma_f32_32x32x16_bf16 v[16:31], v[100:103], v[36:39], v[16:31]
    ds_read_b128 v[36:39], v6 offset:32
    s_waitcnt lgkmcnt(6)
    v_mfma_f32_32x32x16_bf16 v[16:31], v[104:107], v[40:43], v[16:31]
    ds_read_b128 v[40:43], v6 offset:64
    v_mfma_f32_32x32x16_bf16 v[16:31], v[108:111], v[44:47], v[16:31]
    ds_read_b128 v[44:47], v6 offset:96
    s_waitcnt lgkmcnt(6)
    v_mfma_f32_32x32x16_bf16 v[16:31], v[112:115], v[48:51], v[16:31]
    ds_read_b128 v[48:51], v6 offset:128
    v_mfma_f32_32x32x16_bf16 v[16:31], v[116:119], v[52:55], v[16:31]
    ds_read_b128 v[52:55], v6 offset:160
    ds_read_b32 v14, v4 offset:20
    s_waitcnt lgkmcnt(6)
    v_mfma_f32_32x32x16_bf16 v[16:31], v[120:123], v[56:59], v[16:31]
    ds_read_b128 v[56:59], v6 offset:192
    v_readfirstlane_b32 s67, v12
    v_mfma_f32_32x32x16_bf16 v[16:31], v[124:127], v[60:63], v[16:31]
    ds_read_b128 v[60:63], v6 offset:224
    s_nop 10
    v_mul_f32 v16, s68, v16
    v_mul_f32 v17, s68, v17
    v_mul_f32 v18, s68, v18
    v_mul_f32 v19, s68, v19
    v_mul_f32 v20, s68, v20
    v_mul_f32 v21, s68, v21
    v_mul_f32 v22, s68, v22
    v_mul_f32 v23, s68, v23
    v_max3_f32 v12, abs(v16), abs(v17), abs(v18)
    v_max3_f32 v13, abs(v19), abs(v20), abs(v21)
    v_max3_f32 v12, abs(v22), abs(v23), v12
    v_max_f32 v12, v12, v13
    v_cmp_nge_f32 vcc, 0x41e00000, v12
    s_nop 1
    s_cbranch_vccnz U_raw
    v_exp_f32 v16, v16
    v_exp_f32 v17, v17
    v_exp_f32 v18, v18
    v_exp_f32 v19, v19
    v_exp_f32 v20, v20
    v_exp_f32 v21, v21
    v_exp_f32 v22, v22
    v_exp_f32 v23, v23
    v_cvt_pk_bf16_f32 v16, v24, v16
    v_cvt_pk_bf16_f32 v17, v25, v17
    v_cvt_pk_bf16_f32 v18, v26, v18
    v_cvt_pk_bf16_f32 v19, v27, v19
    v_cvt_pk_bf16_f32 v20, v28, v20
    v_cvt_pk_bf16_f32 v21, v29, v21
    v_cvt_pk_bf16_f32 v22, v30, v22
    s_branch K_padB1s
K_padB1:
    s_branch K_padC1
K_padB1s:
    v_cvt_pk_bf16_f32 v23, v31, v23
U_rawr:
    s_waitcnt lgkmcnt(2)
    v_readfirstlane_b32 s61, v14
    s_bitcmp1_b32 s61, s58
    s_cbranch_scc0 U_tw
U_twr:
    ds_write_b128 v10, v[16:19]
    ds_write_b128 v10, v[20:23] offset:32
    s_add_u32 s58, s58, 8
    v_add_u32 v10, 33280, v10
    s_bitcmp1_b32 s67, s56
    s_cbranch_scc0 U_xw
    s_add_u32 s56, s56, 8
    s_branch U_loop
U_xw:
    s_cmp_gt_u32 s56, 18
    s_cbranch_scc1 U_done
sp8:
    ds_read_b32 v12, v4 offset:20
    s_sub_u32 s60, s60, 1
    s_cbranch_scc1 K_exit
    s_waitcnt lgkmcnt(0)
    v_readfirstlane_b32 s61, v12
    s_bitcmp1_b32 s61, s56
    s_cbranch_scc1 sp8d
    s_sleep 1
    s_branch sp8
sp8d:
    ds_read_b128 v[32:35], v6 offset:0
    ds_read_b128 v[36:39], v6 offset:32
    ds_read_b128 v[40:43], v6 offset:64
    ds_read_b128 v[44:47], v6 offset:96
    ds_read_b128 v[48:51], v6 offset:128
    ds_read_b128 v[52:55], v6 offset:160
    ds_read_b128 v[56:59], v6 offset:192
    ds_read_b128 v[60:63], v6 offset:224
    s_add_u32 s56, s56, 8
    s_branch U_loop
U_tw:
sp9:
    ds_read_b32 v12, v4 offset:20
    s_sub_u32 s60, s60, 1
    s_cbranch_scc1 K_exit
    s_waitcnt lgkmcnt(0)
    v_readfirstlane_b32 s61, v12
    s_bitcmp1_b32 s61, s58
    s_cbranch_scc0 sp9
    s_branch U_twr
U_done:
    v_mov_b32 v1, s70
    s_mov_b64 exec, 1
    ds_add_u32 v4, v1 offset:24
    s_mov_b64 exec, -1
    s_branch K_setup
.fill 208, 4, 0xbf800000
K_svc:
    v_lshlrev_b32 v1, 4, v0
    v_lshlrev_b32 v11, 3, v0
    v_lshlrev_b32 v3, 2, v0
    v_lshlrev_b32 v12, 1, v0
    s_lshr_b32 s58, s2, 3
    s_lshl2_add_u32 s58, s58, s53
    s_sub_u32 s58, s58, 3
    s_lshl2_add_u32 s56, s58, s3
    s_mul_i32 s56, s56, 1280
    s_lshr_b32 s57, s56, 1
    s_mov_b32 s42, 640000
    s_mov_b32 s43, 0x00020000
    s_mov_b32 s46, 640000
    s_mov_b32 s47, 0x00020000
    s_mov_b32 s50, 320000
    s_mov_b32 s51, 0x00020000
    s_mov_b32 s30, 512
    s_mov_b32 s67, 0x7fff7fff
    v_mov_b32 v14, 0x100000
    s_bitcmp1_b32 s55, 0
    s_waitcnt lgkmcnt(0)
    s_mov_b64 s[28:29], s[16:17]
    s_cselect_b64 s[36:37], s[20:21], s[14:15]
    s_mov_b64 s[32:33], s[26:27]
    s_mov_b64 s[40:41], s[10:11]
    s_bitcmp1_b32 s2, 2
    s_cbranch_scc1 S_np
    s_cmp_ge_u32 s58, 125
    s_cbranch_scc1 S_clr
    buffer_load_dwordx4 v[16:19], v1, s[40:43], s56 offen
    buffer_load_dword v20, v3, s[40:43], s56 offen offset:1024
    buffer_load_dwordx2 v[120:121], v11, s[28:31], 0 offen
    s_mov_b64 s[48:49], s[6:7]
    s_mov_b64 s[44:45], s[8:9]
    buffer_load_dwordx2 v[28:29], v11, s[48:51], s57 offen
    buffer_load_ushort v30, v12, s[48:51], s57 offen offset:512
    buffer_load_dwordx4 v[22:25], v1, s[44:47], s56 offen
    buffer_load_dword v26, v3, s[44:47], s56 offen offset:1024
    s_barrier
    s_and_b32 s66, s66, 7
    s_lshl_b32 s59, s66, 14
    s_lshl_b32 s61, s66, 13
    s_add_u32 m0, s61, s64
    s_add_u32 s59, s59, s63
    buffer_load_dwordx4 v2, s[36:39], s59 offen offset:0  lds
    buffer_load_dwordx4 v15, s[36:39], s59 offen offset:1024  lds
    buffer_load_dwordx4 v2, s[36:39], s59 offen offset:2048  lds
    buffer_load_dwordx4 v15, s[36:39], s59 offen offset:3072  lds
    s_call_b64 s[70:71], K_touchA
    s_branch S_p2
S_clr:
    s_add_u32 s58, s58, 3
    s_lshl2_add_u32 s58, s58, s3
    s_mul_i32 s59, s58, 6144
    s_add_u32 s59, s59, 21037056
    buffer_store_dwordx4 v[4:7], v1, s[32:35], s59 offen offset:0 sc1
    buffer_store_dwordx4 v[4:7], v1, s[32:35], s59 offen offset:1024 sc1
    buffer_store_dwordx4 v[4:7], v1, s[32:35], s59 offen offset:2048 sc1
    buffer_store_dwordx4 v[4:7], v1, s[32:35], s59 offen offset:3072 sc1
    s_add_u32 s59, s59, 4096
    buffer_store_dwordx4 v[4:7], v1, s[32:35], s59 offen offset:0 sc1
    buffer_store_dwordx4 v[4:7], v1, s[32:35], s59 offen offset:1024 sc1
    s_mul_i32 s59, s3, 2623488
    s_add_u32 s59, s59, 2621440
    v_mov_b32 v16, 0x5f800000
    v_mov_b32 v17, 0x5f800000
    v_mov_b32 v18, 0x5f800000
    v_mov_b32 v19, 0x5f800000
    buffer_store_dwordx4 v[16:19], v1, s[32:35], s59 offen offset:0 sc1
    buffer_store_dwordx4 v[16:19], v1, s[32:35], s59 offen offset:1024 sc1
    buffer_load_dwordx2 v[120:121], v11, s[28:31], 0 offen
    s_barrier
    s_and_b32 s66, s66, 7
    s_lshl_b32 s59, s66, 14
    s_lshl_b32 s61, s66, 13
    s_add_u32 m0, s61, s64
    s_add_u32 s59, s59, s63
    buffer_load_dwordx4 v2, s[36:39], s59 offen offset:0  lds
    buffer_load_dwordx4 v15, s[36:39], s59 offen offset:1024  lds
    buffer_load_dwordx4 v2, s[36:39], s59 offen offset:2048  lds
    buffer_load_dwordx4 v15, s[36:39], s59 offen offset:3072  lds
    s_mov_b32 s40, s24
    s_mov_b32 s41, s25
    s_mov_b32 s42, 0x30
    s_mov_b32 s43, 0x00020000
    s_lshl_b32 s58, s58, 2
    v_mov_b32 v5, 1
    s_mov_b64 exec, 1
    s_waitcnt vmcnt(5)
    buffer_store_dword v5, v4, s[40:43], s58 offen sc1
    s_call_b64 s[70:71], K_touchA
    s_waitcnt vmcnt(1)
    s_branch S_np2
S_np:
    buffer_load_dwordx2 v[120:121], v11, s[28:31], 0 offen
    s_barrier
    s_and_b32 s66, s66, 7
    s_lshl_b32 s59, s66, 14
    s_lshl_b32 s61, s66, 13
    s_add_u32 m0, s61, s64
    s_add_u32 s59, s59, s63
    buffer_load_dwordx4 v2, s[36:39], s59 offen offset:0  lds
    buffer_load_dwordx4 v15, s[36:39], s59 offen offset:1024  lds
    buffer_load_dwordx4 v2, s[36:39], s59 offen offset:2048  lds
    buffer_load_dwordx4 v15, s[36:39], s59 offen offset:3072  lds
    s_call_b64 s[70:71], K_touchA
    v_mov_b32 v5, 1
    s_waitcnt vmcnt(0)
S_np2:
    s_mov_b64 exec, 1
    ds_add_u32 v4, v14 offset:0
    s_mov_b64 exec, -1
    v_and_b32 v122, s67, v120
    v_and_b32 v123, s67, v121
    v_pk_max_u16 v122, v122, v123
    v_lshlrev_b32 v123, 16, v122
    v_max_u32 v122, v122, v123
    s_nop 1
    v_max_u32_dpp v122, v122, v122 row_shr:1 row_mask:0xf bank_mask:0xf
    s_nop 1
    v_max_u32_dpp v122, v122, v122 row_shr:2 row_mask:0xf bank_mask:0xf
    s_nop 1
    v_max_u32_dpp v122, v122, v122 row_shr:4 row_mask:0xf bank_mask:0xf
    s_nop 1
    v_max_u32_dpp v122, v122, v122 row_shr:8 row_mask:0xf bank_mask:0xf
    s_nop 1
    v_max_u32_dpp v122, v122, v122 row_bcast:15 row_mask:0xa bank_mask:0xf
    s_nop 1
    v_max_u32_dpp v122, v122, v122 row_bcast:31 row_mask:0xc bank_mask:0xf
    v_and_b32 v122, 0xffff0000, v122
    v_max_u32 v122, 0x21800000, v122
    v_mul_f32 v122, 0x4338aa3b, v122
    s_mov_b32 s28, s24
    s_mov_b32 s29, s25
    s_mov_b32 s30, 0x30
    s_mov_b32 s31, 0x00020000
    v_readlane_b32 s64, v122, 63
    s_mov_b32 s68, 4
    s_setprio 3
    s_call_b64 s[70:71], K_touchB
sp12:
    ds_read_b32 v8, v4 offset:0
    s_sub_u32 s60, s60, 1
    s_cbranch_scc1 K_exit
    s_waitcnt lgkmcnt(0)
    v_readfirstlane_b32 s61, v8
    s_bitcmp1_b32 s61, 10
    s_cbranch_scc1 sp12d
    s_sleep 2
    s_branch sp12
sp12d:
    s_branch S_join
K_touchA:
    s_bitcmp1_b32 s55, 1
    s_cbranch_scc1 K_touchAh
    s_bitcmp1_b32 s55, 0
    s_cbranch_scc1 K_padA1
    s_branch K_padA0
K_touchAh:
    s_bitcmp1_b32 s55, 0
    s_cbranch_scc1 K_padA3
    s_branch K_padA2
K_touchB:
    s_bitcmp1_b32 s55, 1
    s_cbranch_scc1 K_touchBh
    s_bitcmp1_b32 s55, 0
    s_cbranch_scc1 K_padB1
    s_branch K_padB0
K_touchBh:
    s_bitcmp1_b32 s55, 0
    s_cbranch_scc1 K_padB3
    s_branch K_padB2
S_p2:
    v_mov_b32 v5, 1
    v_mov_b32 v6, 8
    s_mul_i32 s59, s58, 10240
    s_mul_i32 s65, s3, 2560
    s_add_u32 s59, s59, s65
    s_add_u32 s59, s59, 22020096
    s_lshl_b32 s58, s58, 5
    s_add_u32 s58, s58, 21037056
    s_movk_i32 s66, 65378
    v_mov_b32 v13, 0x4b003000
    s_mov_b32 s69, 0x0c040100
    v_add_u32 v9, s65, v1
    v_add_u32 v10, s65, v11
    s_waitcnt vmcnt(10)
    v_mul_u32_u24 v48, 26547, v16
    v_lshrrev_b32 v48, 20, v48
    v_and_b32 v48, 0xfc, v48
    ds_add_rtn_u32 v32, v48, v6 offset:1040
    v_mul_u32_u24 v49, 26547, v17
    v_lshrrev_b32 v49, 20, v49
    v_and_b32 v49, 0xfc, v49
    ds_add_rtn_u32 v33, v49, v6 offset:1040
    v_mul_u32_u24 v50, 26547, v18
    v_lshrrev_b32 v50, 20, v50
    v_and_b32 v50, 0xfc, v50
    ds_add_rtn_u32 v34, v50, v6 offset:1040
    v_mul_u32_u24 v51, 26547, v19
    s_branch K_padA1s
K_padA1:
    s_setpc_b64 s[70:71]
K_padA1s:
    v_lshrrev_b32 v51, 20, v51
    v_and_b32 v51, 0xfc, v51
    ds_add_rtn_u32 v35, v51, v6 offset:1040
    s_waitcnt vmcnt(9)
    v_mul_u32_u24 v52, 26547, v20
    v_lshrrev_b32 v52, 20, v52
    v_and_b32 v52, 0xfc, v52
    ds_add_rtn_u32 v36, v52, v6 offset:1040
    s_mov_b64 exec, 1
    ds_add_u32 v4, v5 offset:32
    s_mov_b64 exec, -1
    s_waitcnt vmcnt(8)
    v_and_b32 v122, s67, v120
    v_and_b32 v123, s67, v121
    v_pk_max_u16 v122, v122, v123
    v_lshlrev_b32 v123, 16, v122
    v_max_u32 v122, v122, v123
    v_lshlrev_b32 v16, 2, v16
    v_mad_i32_i24 v39, v48, s66, v16
    v_max_u32_dpp v122, v122, v122 row_shr:1 row_mask:0xf bank_mask:0xf
    v_lshlrev_b32 v17, 2, v17
    v_mad_i32_i24 v41, v49, s66, v17
    v_max_u32_dpp v122, v122, v122 row_shr:2 row_mask:0xf bank_mask:0xf
    v_lshlrev_b32 v18, 2, v18
    v_mad_i32_i24 v43, v50, s66, v18
    v_max_u32_dpp v122, v122, v122 row_shr:4 row_mask:0xf bank_mask:0xf
    v_lshlrev_b32 v19, 2, v19
    v_mad_i32_i24 v45, v51, s66, v19
    v_max_u32_dpp v122, v122, v122 row_shr:8 row_mask:0xf bank_mask:0xf
    v_lshlrev_b32 v20, 2, v20
    v_mad_i32_i24 v47, v52, s66, v20
    v_max_u32_dpp v122, v122, v122 row_bcast:15 row_mask:0xa bank_mask:0xf
    s_nop 1
    v_max_u32_dpp v122, v122, v122 row_bcast:31 row_mask:0xc bank_mask:0xf
    v_and_b32 v122, 0xffff0000, v122
    v_max_u32 v122, 0x21800000, v122
    v_mul_f32 v122, 0x4338aa3b, v122
    s_waitcnt vmcnt(6)
    v_and_b32 v54, s67, v28
    v_readlane_b32 s64, v122, 63
    v_and_b32 v55, s67, v29
    v_and_b32 v56, s67, v30
    v_lshlrev_b32 v38, 16, v28
    v_and_b32 v40, 0xffff0000, v28
    v_lshlrev_b32 v42, 16, v29
    v_and_b32 v44, 0xffff0000, v29
    v_lshlrev_b32 v46, 16, v30
    v_fma_f32 v38, v38, s64, v13
    v_fma_f32 v40, v40, s64, v13
    v_fma_f32 v42, v42, s64, v13
    v_fma_f32 v44, v44, s64, v13
    v_fma_f32 v46, v46, s64, v13
sp10:
    ds_read_b32 v8, v4 offset:32
    s_sub_u32 s60, s60, 1
    s_cbranch_scc1 K_exit
    s_waitcnt lgkmcnt(0)
    v_readfirstlane_b32 s61, v8
    s_cmp_eq_u32 s61, 4
    s_cbranch_scc0 sp10
    ds_read_b32 v8, v3 offset:1040
    v_pk_max_u16 v54, v54, v55
    v_pk_max_u16 v54, v54, v56
    v_lshlrev_b32 v55, 16, v54
    v_max_u32 v54, v54, v55
    v_mul_f32 v54, s64, v54
    s_cmp_ge_u32 s64, 0x71800000
    v_cmp_nge_f32 vcc, 0x457ff000, v54
    v_lshrrev_b32 v58, 7, v38
    v_or_b32 v38, 0x80, v38
    v_lshrrev_b32 v59, 7, v40
    v_or_b32 v40, 0x80, v40
    v_lshrrev_b32 v60, 7, v42
    v_or_b32 v42, 0x80, v42
    v_lshrrev_b32 v61, 7, v44
    v_or_b32 v44, 0x80, v44
    v_lshrrev_b32 v62, 7, v46
    v_or_b32 v46, 0x80, v46
    s_cselect_b64 vcc, -1, vcc
    s_waitcnt vmcnt(4) lgkmcnt(0)
    v_mov_b32 v13, v8
    v_perm_b32 v38, v38, v22, s69
    v_lshl_or_b32 v38, v58, 24, v38
    v_add_u32_dpp v13, v13, v13 row_shr:1 row_mask:0xf bank_mask:0xf bound_ctrl:0
    v_perm_b32 v40, v40, v23, s69
    v_lshl_or_b32 v40, v59, 24, v40
    v_add_u32_dpp v13, v13, v13 row_shr:2 row_mask:0xf bank_mask:0xf bound_ctrl:0
    v_perm_b32 v42, v42, v24, s69
    v_lshl_or_b32 v42, v60, 24, v42
    v_add_u32_dpp v13, v13, v13 row_shr:4 row_mask:0xf bank_mask:0xf bound_ctrl:0
    v_perm_b32 v44, v44, v25, s69
    v_lshl_or_b32 v44, v61, 24, v44
    v_add_u32_dpp v13, v13, v13 row_shr:8 row_mask:0xf bank_mask:0xf bound_ctrl:0
    v_perm_b32 v46, v46, v26, s69
    v_lshl_or_b32 v46, v62, 24, v46
    v_add_u32_dpp v13, v13, v13 row_bcast:15 row_mask:0xa bank_mask:0xf
    s_nop 1
    v_add_u32_dpp v13, v13, v13 row_bcast:31 row_mask:0xc bank_mask:0xf
    v_sub_u32 v13, v13, v8
    s_cmp_lg_u64 vcc, 0
    ds_bpermute_b32 v16, v48, v13
    ds_bpermute_b32 v17, v49, v13
    ds_bpermute_b32 v18, v50, v13
    ds_bpermute_b32 v19, v51, v13
    ds_bpermute_b32 v20, v52, v13
    s_cbranch_scc0 H_4
    v_mov_b32 v39, 640
    v_mov_b32 v41, 640
    v_mov_b32 v43, 640
    v_mov_b32 v45, 640
    v_mov_b32 v47, 640
H_4:
    v_lshl_or_b32 v13, v8, 13, v13
    v_or_b32 v13, 0x80000000, v13
    s_waitcnt lgkmcnt(4)
    v_add_u32 v16, v32, v16
    ds_write_b64 v16, v[38:39] offset:2384
    s_waitcnt lgkmcnt(4)
    v_add_u32 v17, v33, v17
    ds_write_b64 v17, v[40:41] offset:2384
    s_waitcnt lgkmcnt(4)
    v_add_u32 v18, v34, v18
    ds_write_b64 v18, v[42:43] offset:2384
    s_waitcnt lgkmcnt(4)
    v_add_u32 v19, v35, v19
    ds_write_b64 v19, v[44:45] offset:2384
    s_waitcnt lgkmcnt(4)
    v_add_u32 v20, v36, v20
    ds_write_b64 v20, v[46:47] offset:2384
    s_mov_b64 exec, 1
    ds_add_u32 v4, v5 offset:36
    s_waitcnt vmcnt(0)
    ds_add_u32 v4, v14 offset:0
    s_branch K_padA3s
K_padA3:
    s_setpc_b64 s[70:71]
K_padA3s:
    s_mov_b64 exec, -1
    s_mov_b32 s28, s24
    s_mov_b32 s29, s25
    s_mov_b32 s30, 0x30
    s_mov_b32 s31, 0x00020000
sp11:
    ds_read_b32 v8, v4 offset:36
    s_sub_u32 s60, s60, 1
    s_cbranch_scc1 K_exit
    s_waitcnt lgkmcnt(0)
    v_readfirstlane_b32 s61, v8
    s_cmp_eq_u32 s61, 4
    s_cbranch_scc0 sp11
    ds_read_b128 v[16:19], v9 offset:2384
    ds_read_b128 v[20:23], v9 offset:3408
    ds_read_b64 v[24:25], v10 offset:4432
    s_waitcnt lgkmcnt(2)
    buffer_store_dwordx4 v[16:19], v1, s[32:35], s59 offen sc1
    s_waitcnt lgkmcnt(1)
    buffer_store_dwordx4 v[20:23], v1, s[32:35], s59 offen offset:1024 sc1
    s_waitcnt lgkmcnt(0)
    buffer_store_dwordx2 v[24:25], v11, s[32:35], s59 offen offset:2048 sc1
    s_call_b64 s[70:71], K_touchB
    s_mov_b32 s68, 3
S_join:
    v_mov_b32 v7, 16
    s_cmp_lg_u32 s3, 0
    s_cbranch_scc1 S_j2
    buffer_load_dword v12, v3, s[28:31], 0 offen sc1
    s_lshl_b32 s61, s53, 4
    v_rcp_f32 v123, s64
    v_lshlrev_b32 v124, 16, v120
    v_and_b32 v125, 0xffff0000, v120
    v_lshlrev_b32 v126, 16, v121
    v_and_b32 v127, 0xffff0000, v121
    v_mul_f32 v123, 0xbfb8aa3b, v123
    v_and_b32 v9, 0xf0, v1
    v_mov_b32 v10, 0x6080ffff
    s_lshl_b64 exec, 0xffff, s61
    v_mul_f32 v124, v123, v124
    v_mul_f32 v125, v123, v125
    v_mul_f32 v126, v123, v126
    v_mul_f32 v127, v123, v127
    ds_write_b128 v9, v[124:127] offset:2064
    s_mov_b64 exec, 0xffff
    ds_write_b32 v3, v10 offset:2320
    s_waitcnt vmcnt(1)
    s_branch S_j3
S_j2:
    s_waitcnt vmcnt(0)
S_j3:
    s_mov_b64 exec, 1
    ds_add_rtn_u32 v8, v4, v7 offset:12
    s_mov_b64 exec, -1
    v_lshrrev_b32 v11, 3, v0
    v_and_b32 v9, 7, v0
    v_lshlrev_b32 v10, 2, v9
    v_lshl_add_u32 v11, v11, 12, v10
    s_lshr_b32 s56, s100, 3
    s_lshl_b32 s56, s56, 12
    s_and_b32 s61, s100, 7
    s_lshl2_add_u32 s56, s61, s56
    s_lshl_b32 s61, s3, 10
    s_add_u32 s56, s56, s61
    s_add_u32 s56, s56, 21037056
    s_waitcnt lgkmcnt(0)
    v_readfirstlane_b32 s61, v8
    s_lshr_b32 s61, s61, 4
    s_cmp_eq_u32 s61, s68
    s_cselect_b32 s68, 1, 0
    s_cbranch_scc0 S_pub
S_pub:
    v_lshrrev_b32 v2, 4, v0
    v_lshl_add_u32 v2, v2, 3, v9
    v_add_u32 v14, 2384, v1
    v_and_b32 v10, 0xf0, v1
    v_lshlrev_b32 v1, 5, v2
    v_mul_u32_u24 v2, 10240, v2
    v_lshrrev_b32 v9, 3, v10
    s_cmp_eq_u32 s3, 3
    s_cselect_b32 s67, 0x1f1fffff, -1
    v_mov_b32 v16, 0x80000000
    s_mul_i32 s57, s3, 327680
    s_add_u32 s57, s57, 22020096
    v_mov_b32 v6, 4
    s_movk_i32 s61, 176
    v_mov_b32 v36, 2384
    v_mad_u32_u24 v36, v0, s61, v36
    v_add_u32 v37, 11264, v36
    v_add_u32 v38, 22528, v36
    ds_write_b32 v3, v36 offset:128
    ds_write_b32 v3, v37 offset:384
    s_mov_b32 exec_hi, 15
    ds_write_b32 v3, v38 offset:640
    s_mov_b32 exec_hi, -1
    s_mul_i32 s61, s3, 7168
    v_add_u32 v14, s61, v14
    v_and_b32 v40, 7, v0
    v_or_b32 v40, 0x60802800, v40
    v_add_u32 v41, 2, v0
    v_and_b32 v41, 7, v41
    v_or_b32 v41, 0x60802800, v41
    v_add_u32 v42, 5, v0
    v_and_b32 v42, 7, v42
    v_or_b32 v42, 0x60802800, v42
    v_add_u32 v43, 7, v0
    v_and_b32 v43, 7, v43
    v_or_b32 v43, 0x60802800, v43
    s_mov_b32 s70, 0
    s_cmp_lg_u32 s3, 0
    s_cbranch_scc1 S_j4
    s_mov_b64 exec, 4095
    s_waitcnt vmcnt(0)
H_rdy:
    v_cmp_eq_u32 vcc, 0, v12
    s_nop 0
    s_cbranch_vccz H_ok
    s_sleep 2
    buffer_load_dword v12, v3, s[28:31], 0 offen sc1
    s_sub_u32 s62, s62, 1
    s_waitcnt vmcnt(0)
    s_cbranch_scc0 H_rdy
    s_mov_b32 s62, 0
    v_mov_b32 v5, 3
H_ok:
    s_mov_b64 exec, 1
    ds_write_b32 v4, v5 offset:28
    v_mov_b32 v5, 1
    s_mov_b64 exec, -1
    s_branch S_j5
S_j4:
S_j4b:
sp13:
    ds_read_b32 v8, v4 offset:28
    s_sub_u32 s60, s60, 1
    s_cbranch_scc1 K_exit
    s_waitcnt lgkmcnt(0)
    v_readfirstlane_b32 s61, v8
    s_cmp_lg_u32 s61, 0
    s_cbranch_scc1 sp13d
    s_sleep 1
    s_branch sp13
sp13d:
    s_bitcmp1_b32 s61, 1
    s_cselect_b32 s62, 0, s62
S_j5:
    s_cmp_lg_u32 s68, 0
    s_cbranch_scc0 S_pub2
    buffer_store_dword v13, v11, s[32:35], s58 offen sc1
S_pub2:
    v_lshrrev_b32 v45, 5, v0
    v_and_b32 v44, 31, v0
    v_lshlrev_b32 v44, 4, v44
    v_lshl_add_u32 v44, v45, 13, v44
    v_mov_b32 v45, 0x1000
    s_mov_b64 s[36:37], s[4:5]
    s_mov_b32 s38, 5120000
    s_lshl_b32 s46, s52, 9
    s_lshl_b32 s61, s3, 11
    s_add_u32 s46, s46, s61
    s_add_u32 s61, s53, 3
    s_sub_u32 s44, s61, 5
    s_min_u32 s61, s61, s44
    s_lshl_b32 s61, s61, 14
    s_add_u32 s44, s61, s46
    s_add_u32 s61, s53, 4
    s_sub_u32 s45, s61, 5
    s_min_u32 s61, s61, s45
    s_lshl_b32 s61, s61, 14
    s_add_u32 s45, s61, s46
    s_mul_i32 s46, s3, 4160
    s_add_u32 m0, s46, 130560
sp14:
    ds_read_b32 v8, v4 offset:40
    s_sub_u32 s60, s60, 1
    s_cbranch_scc1 K_exit
    s_waitcnt lgkmcnt(0)
    v_readfirstlane_b32 s61, v8
    s_cmp_ge_u32 s61, 16
    s_cbranch_scc1 sp14d
    s_sleep 1
    s_branch sp14
sp14d:
    buffer_load_dwordx4 v44, s[36:39], s44 offen offset:0 lds
    s_add_u32 m0, m0, 528
    s_nop 0
    buffer_load_dwordx4 v44, s[36:39], s44 offen offset:512 lds
    s_add_u32 m0, m0, 528
    s_nop 0
    buffer_load_dwordx4 v44, s[36:39], s44 offen offset:1024 lds
    s_add_u32 m0, m0, 528
    s_nop 0
    buffer_load_dwordx4 v44, s[36:39], s44 offen offset:1536 lds
    s_add_u32 m0, m0, 15056
    s_nop 0
    buffer_load_dwordx4 v44, s[36:39], s45 offen offset:0 lds
    s_add_u32 m0, m0, 528
    s_nop 0
    buffer_load_dwordx4 v44, s[36:39], s45 offen offset:512 lds
    s_add_u32 m0, m0, 528
    s_nop 0
    buffer_load_dwordx4 v44, s[36:39], s45 offen offset:1024 lds
    s_add_u32 m0, m0, 528
    s_nop 0
    buffer_load_dwordx4 v44, s[36:39], s45 offen offset:1536 lds
    s_waitcnt vmcnt(4)
    s_mov_b64 exec, 1
    ds_add_u32 v4, v45 offset:0
    s_mov_b64 exec, -1
    v_mov_b32 v45, 0x10000
sp15:
    ds_read_b32 v8, v4 offset:0
    s_sub_u32 s60, s60, 1
    s_cbranch_scc1 K_exit
    s_waitcnt lgkmcnt(0)
    v_readfirstlane_b32 s61, v8
    s_bitcmp1_b32 s61, 14
    s_cbranch_scc1 sp15d
    s_sleep 2
    s_branch sp15
K_padB2:
    s_branch K_padC2
sp15d:
S_poll:
    s_mov_b32 exec_hi, s67
    buffer_load_dword v16, v1, s[32:35], s56 offen sc1
    s_mov_b32 exec_hi, -1
S_pollw:
    s_waitcnt vmcnt(1)
    s_mov_b64 exec, 1
    ds_add_u32 v4, v45 offset:0
    s_mov_b64 exec, -1
    v_mov_b32 v45, 0
    s_sub_u32 s62, s62, 1
    s_cbranch_scc1 S_to
    s_waitcnt vmcnt(0)
    v_cmp_le_i32 vcc, 0, v16
    s_nop 0
    s_cbranch_vccz S_go
    s_sleep 8
    s_branch S_poll
S_to:
    s_mov_b32 s62, 0
    s_waitcnt vmcnt(0)
    v_mov_b32 v7, 0x80000000
    s_mov_b64 exec, 1
    ds_or_b32 v4, v7 offset:24
    s_mov_b64 exec, -1
    v_mov_b32 v16, 0
S_go:
    s_setprio 3
    v_and_b32 v17, 0xffff, v16
    v_bfe_u32 v18, v16, 16, 11
    v_add_u32 v17, v17, v2
S_rnd:
    v_cmp_lt_i32 s[64:65], 32, v18
    s_nop 0
    v_sub_u32_dpp v28, v18, v9 row_newbcast:0 row_mask:0xf bank_mask:0xf
    v_add_u32_dpp v20, v17, v10 row_newbcast:0 row_mask:0xf bank_mask:0xf
    v_sub_u32_dpp v29, v18, v9 row_newbcast:1 row_mask:0xf bank_mask:0xf
    v_add_u32_dpp v21, v17, v10 row_newbcast:1 row_mask:0xf bank_mask:0xf
    v_sub_u32_dpp v30, v18, v9 row_newbcast:2 row_mask:0xf bank_mask:0xf
    v_add_u32_dpp v22, v17, v10 row_newbcast:2 row_mask:0xf bank_mask:0xf
    v_sub_u32_dpp v31, v18, v9 row_newbcast:3 row_mask:0xf bank_mask:0xf
    v_add_u32_dpp v23, v17, v10 row_newbcast:3 row_mask:0xf bank_mask:0xf
    v_sub_u32_dpp v32, v18, v9 row_newbcast:4 row_mask:0xf bank_mask:0xf
    v_add_u32_dpp v24, v17, v10 row_newbcast:4 row_mask:0xf bank_mask:0xf
    v_sub_u32_dpp v33, v18, v9 row_newbcast:5 row_mask:0xf bank_mask:0xf
    v_add_u32_dpp v25, v17, v10 row_newbcast:5 row_mask:0xf bank_mask:0xf
    v_sub_u32_dpp v34, v18, v9 row_newbcast:6 row_mask:0xf bank_mask:0xf
    v_add_u32_dpp v26, v17, v10 row_newbcast:6 row_mask:0xf bank_mask:0xf
    v_sub_u32_dpp v35, v18, v9 row_newbcast:7 row_mask:0xf bank_mask:0xf
    v_add_u32_dpp v27, v17, v10 row_newbcast:7 row_mask:0xf bank_mask:0xf
    v_cmpx_lt_i32 vcc, 0, v28
    buffer_load_dwordx4 v[64:67], v20, s[32:35], s57 offen sc1
    s_mov_b64 exec, -1
    v_cmpx_lt_i32 vcc, 0, v29
    buffer_load_dwordx4 v[68:71], v21, s[32:35], s57 offen sc1
    s_mov_b64 exec, -1
    v_cmpx_lt_i32 vcc, 0, v30
    buffer_load_dwordx4 v[72:75], v22, s[32:35], s57 offen sc1
    s_mov_b64 exec, -1
    v_cmpx_lt_i32 vcc, 0, v31
    buffer_load_dwordx4 v[76:79], v23, s[32:35], s57 offen sc1
    s_mov_b64 exec, -1
    v_cmpx_lt_i32 vcc, 0, v32
    buffer_load_dwordx4 v[80:83], v24, s[32:35], s57 offen sc1
    s_mov_b64 exec, -1
    v_cmpx_lt_i32 vcc, 0, v33
    buffer_load_dwordx4 v[84:87], v25, s[32:35], s57 offen sc1
    s_mov_b64 exec, -1
    v_cmpx_lt_i32 vcc, 0, v34
    buffer_load_dwordx4 v[88:91], v26, s[32:35], s57 offen sc1
    s_mov_b64 exec, -1
    v_cmpx_lt_i32 vcc, 0, v35
    buffer_load_dwordx4 v[92:95], v27, s[32:35], s57 offen sc1
    s_mov_b64 exec, -1
    s_cmp_lg_u64 s[64:65], 0
    s_cbranch_scc1 S_h2
S_h2r:
    s_cmp_lg_u32 s70, 0
    s_cbranch_scc1 S_pfd
sp16:
    ds_read_b32 v8, v4 offset:12
    s_sub_u32 s60, s60, 1
    s_cbranch_scc1 K_exit
    s_waitcnt lgkmcnt(0)
    v_readfirstlane_b32 s61, v8
    s_cmp_ge_u32 s61, 72
    s_cbranch_scc1 sp16d
    s_sleep 1
    s_branch sp16
sp16d:
    v_mov_b32 v7, 0x100
    ds_write_b128 v14, v[40:43] offset:0
    ds_write_b128 v14, v[40:43] offset:1024
    ds_write_b128 v14, v[40:43] offset:2048
    ds_write_b128 v14, v[40:43] offset:3072
    ds_write_b128 v14, v[40:43] offset:4096
    ds_write_b128 v14, v[40:43] offset:5120
    ds_write_b128 v14, v[40:43] offset:6144
    s_mov_b64 exec, 1
    ds_add_u32 v4, v7 offset:12
    s_mov_b64 exec, -1
sp17:
    ds_read_b32 v8, v4 offset:12
    s_sub_u32 s60, s60, 1
    s_cbranch_scc1 K_exit
    s_waitcnt lgkmcnt(0)
    v_readfirstlane_b32 s61, v8
    s_bitcmp1_b32 s61, 10
    s_cbranch_scc0 sp17
S_pfd:
    s_waitcnt vmcnt(7)
    v_cmpx_lt_i32 vcc, 0, v28
    ds_add_rtn_u32 v65, v65, v6 offset:128
    v_cmpx_lt_i32 vcc, 1, v28
    ds_add_rtn_u32 v67, v67, v6 offset:128
    s_mov_b64 exec, -1
    s_waitcnt vmcnt(6)
    v_cmpx_lt_i32 vcc, 0, v29
    ds_add_rtn_u32 v69, v69, v6 offset:128
    v_cmpx_lt_i32 vcc, 1, v29
    ds_add_rtn_u32 v71, v71, v6 offset:128
    s_mov_b64 exec, -1
    s_waitcnt vmcnt(5)
    v_cmpx_lt_i32 vcc, 0, v30
    ds_add_rtn_u32 v73, v73, v6 offset:128
    v_cmpx_lt_i32 vcc, 1, v30
    ds_add_rtn_u32 v75, v75, v6 offset:128
    s_mov_b64 exec, -1
    s_waitcnt vmcnt(4)
    v_cmpx_lt_i32 vcc, 0, v31
    ds_add_rtn_u32 v77, v77, v6 offset:128
    v_cmpx_lt_i32 vcc, 1, v31
    ds_add_rtn_u32 v79, v79, v6 offset:128
    s_mov_b64 exec, -1
    s_waitcnt vmcnt(3)
    v_cmpx_lt_i32 vcc, 0, v32
    ds_add_rtn_u32 v81, v81, v6 offset:128
    v_cmpx_lt_i32 vcc, 1, v32
    ds_add_rtn_u32 v83, v83, v6 offset:128
    s_mov_b64 exec, -1
    s_waitcnt vmcnt(2)
    v_cmpx_lt_i32 vcc, 0, v33
    ds_add_rtn_u32 v85, v85, v6 offset:128
    v_cmpx_lt_i32 vcc, 1, v33
    ds_add_rtn_u32 v87, v87, v6 offset:128
    s_mov_b64 exec, -1
    s_waitcnt vmcnt(1)
    v_cmpx_lt_i32 vcc, 0, v34
    ds_add_rtn_u32 v89, v89, v6 offset:128
    v_cmpx_lt_i32 vcc, 1, v34
    ds_add_rtn_u32 v91, v91, v6 offset:128
    s_mov_b64 exec, -1
    s_waitcnt vmcnt(0)
    v_cmpx_lt_i32 vcc, 0, v35
    ds_add_rtn_u32 v93, v93, v6 offset:128
    v_cmpx_lt_i32 vcc, 1, v35
    ds_add_rtn_u32 v95, v95, v6 offset:128
    s_mov_b64 exec, -1
    s_waitcnt lgkmcnt(14)
    v_min_u32 v65, 30716, v65
    v_min_u32 v67, 30716, v67
    v_cmpx_lt_i32 vcc, 0, v28
    ds_write_b32 v65, v64
    v_cmpx_lt_i32 vcc, 1, v28
    ds_write_b32 v67, v66
    s_mov_b64 exec, -1
    s_waitcnt lgkmcnt(14)
    v_min_u32 v69, 30716, v69
    v_min_u32 v71, 30716, v71
    v_cmpx_lt_i32 vcc, 0, v29
    ds_write_b32 v69, v68
    v_cmpx_lt_i32 vcc, 1, v29
    ds_write_b32 v71, v70
    s_mov_b64 exec, -1
    s_waitcnt lgkmcnt(14)
    v_min_u32 v73, 30716, v73
    v_min_u32 v75, 30716, v75
    v_cmpx_lt_i32 vcc, 0, v30
    ds_write_b32 v73, v72
    v_cmpx_lt_i32 vcc, 1, v30
    ds_write_b32 v75, v74
    s_mov_b64 exec, -1
    s_waitcnt lgkmcnt(14)
    v_min_u32 v77, 30716, v77
    v_min_u32 v79, 30716, v79
    v_cmpx_lt_i32 vcc, 0, v31
    ds_write_b32 v77, v76
    v_cmpx_lt_i32 vcc, 1, v31
    ds_write_b32 v79, v78
    s_mov_b64 exec, -1
    s_waitcnt lgkmcnt(14)
    v_min_u32 v81, 30716, v81
    v_min_u32 v83, 30716, v83
    v_cmpx_lt_i32 vcc, 0, v32
    ds_write_b32 v81, v80
    v_cmpx_lt_i32 vcc, 1, v32
    ds_write_b32 v83, v82
    s_mov_b64 exec, -1
    s_branch K_padB3s
K_padB3:
    s_branch K_padC3
K_padB3s:
    s_waitcnt lgkmcnt(14)
    v_min_u32 v85, 30716, v85
    v_min_u32 v87, 30716, v87
    v_cmpx_lt_i32 vcc, 0, v33
    ds_write_b32 v85, v84
    v_cmpx_lt_i32 vcc, 1, v33
    ds_write_b32 v87, v86
    s_mov_b64 exec, -1
    s_waitcnt lgkmcnt(14)
    v_min_u32 v89, 30716, v89
    v_min_u32 v91, 30716, v91
    v_cmpx_lt_i32 vcc, 0, v34
    ds_write_b32 v89, v88
    v_cmpx_lt_i32 vcc, 1, v34
    ds_write_b32 v91, v90
    s_mov_b64 exec, -1
    s_waitcnt lgkmcnt(14)
    v_min_u32 v93, 30716, v93
    v_min_u32 v95, 30716, v95
    v_cmpx_lt_i32 vcc, 0, v35
    ds_write_b32 v93, v92
    v_cmpx_lt_i32 vcc, 1, v35
    ds_write_b32 v95, v94
    s_mov_b64 exec, -1
    s_cmp_lg_u64 s[64:65], 0
    s_cbranch_scc1 S_h3
S_h3r:
    s_mov_b64 exec, 1
    ds_add_rtn_u32 v8, v4, v5 offset:44
    s_mov_b64 exec, -1
    ds_read_b32 v24, v3 offset:128
    ds_read_b32 v25, v3 offset:384
    ds_read_b32 v26, v3 offset:640
    v_add_u32 v10, 256, v3
    v_add_u32 v11, 512, v3
    s_waitcnt lgkmcnt(0)
    v_readfirstlane_b32 s61, v8
    v_sub_u32 v24, v24, v36
    v_sub_u32 v25, v25, v37
    v_sub_u32 v26, v26, v38
    s_cmp_eq_u32 s61, 3
    s_cbranch_scc0 K_setup
    v_readlane_b32 s66, v26, 32
    s_mov_b32 exec_hi, 0
    v_min_u32 v34, 252, v26
    v_sub_u32 v34, 252, v34
    ds_add_rtn_u32 v30, v34, v6 offset:784
    v_cmp_lt_u32 vcc, 176, v26
    s_mov_b64 exec, -1
    v_min_u32 v32, 252, v24
    v_sub_u32 v32, 252, v32
    ds_add_rtn_u32 v28, v32, v6 offset:784
    v_min_u32 v33, 252, v25
    v_sub_u32 v33, 252, v33
    ds_add_rtn_u32 v29, v33, v6 offset:784
    ds_read_b32 v8, v3 offset:784
    s_or_b32 s66, s66, vcc_lo
    v_max_u32 v7, v24, v25
    v_cmp_lt_u32 vcc, 176, v7
    v_lshl_or_b32 v24, v24, 16, v3
    v_lshl_or_b32 v25, v25, 16, v10
    v_lshl_or_b32 v26, v26, 16, v11
    s_or_b32 s66, s66, vcc_lo
    s_or_b32 s66, s66, vcc_hi
    s_cselect_b32 s61, 65536, 0
    s_bitset1_b32 s61, 12
    s_waitcnt lgkmcnt(0)
    v_mov_b32 v7, v8
    s_nop 1
    v_add_u32_dpp v7, v7, v7 row_shr:1 row_mask:0xf bank_mask:0xf bound_ctrl:0
    s_nop 1
    v_add_u32_dpp v7, v7, v7 row_shr:2 row_mask:0xf bank_mask:0xf bound_ctrl:0
    s_nop 1
    v_add_u32_dpp v7, v7, v7 row_shr:4 row_mask:0xf bank_mask:0xf bound_ctrl:0
    s_nop 1
    v_add_u32_dpp v7, v7, v7 row_shr:8 row_mask:0xf bank_mask:0xf bound_ctrl:0
    s_nop 1
    v_add_u32_dpp v7, v7, v7 row_bcast:15 row_mask:0xa bank_mask:0xf
    s_nop 1
    v_add_u32_dpp v7, v7, v7 row_bcast:31 row_mask:0xc bank_mask:0xf
    v_sub_u32 v7, v7, v8
    ds_bpermute_b32 v32, v32, v7
    ds_bpermute_b32 v33, v33, v7
    ds_bpermute_b32 v34, v34, v7
    v_mov_b32 v7, s61
    s_waitcnt lgkmcnt(2)
    v_add_u32 v32, v32, v28
    ds_write_b32 v32, v24 offset:1296
    s_waitcnt lgkmcnt(2)
    v_add_u32 v33, v33, v29
    ds_write_b32 v33, v25 offset:1296
    s_waitcnt lgkmcnt(2)
    v_add_u32 v34, v34, v30
    s_mov_b32 exec_hi, 0
    ds_write_b32 v34, v26 offset:1296
    s_mov_b64 exec, 1
    ds_add_u32 v4, v7 offset:24
    s_mov_b64 exec, -1
    s_branch K_setup
S_h2:
    v_cmpx_lt_i32 vcc, 32, v28
    s_cbranch_execz S_h2_0
    buffer_load_dwordx4 v[96:99], v20, s[32:35], s57 offen offset:256 sc1
S_h2_0:
    s_mov_b64 exec, -1
    v_cmpx_lt_i32 vcc, 32, v29
    s_cbranch_execz S_h2_1
    buffer_load_dwordx4 v[100:103], v21, s[32:35], s57 offen offset:256 sc1
S_h2_1:
    s_mov_b64 exec, -1
    v_cmpx_lt_i32 vcc, 32, v30
    s_cbranch_execz S_h2_2
    buffer_load_dwordx4 v[104:107], v22, s[32:35], s57 offen offset:256 sc1
S_h2_2:
    s_mov_b64 exec, -1
    v_cmpx_lt_i32 vcc, 32, v31
    s_cbranch_execz S_h2_3
    buffer_load_dwordx4 v[108:111], v23, s[32:35], s57 offen offset:256 sc1
S_h2_3:
    s_mov_b64 exec, -1
    v_cmpx_lt_i32 vcc, 32, v32
    s_cbranch_execz S_h2_4
    buffer_load_dwordx4 v[112:115], v24, s[32:35], s57 offen offset:256 sc1
S_h2_4:
    s_mov_b64 exec, -1
    v_cmpx_lt_i32 vcc, 32, v33
    s_cbranch_execz S_h2_5
    buffer_load_dwordx4 v[116:119], v25, s[32:35], s57 offen offset:256 sc1
S_h2_5:
    s_mov_b64 exec, -1
    v_cmpx_lt_i32 vcc, 32, v34
    s_cbranch_execz S_h2_6
    buffer_load_dwordx4 v[120:123], v26, s[32:35], s57 offen offset:256 sc1
S_h2_6:
    s_mov_b64 exec, -1
    v_cmpx_lt_i32 vcc, 32, v35
    s_cbranch_execz S_h2_7
    buffer_load_dwordx4 v[124:127], v27, s[32:35], s57 offen offset:256 sc1
S_h2_7:
    s_mov_b64 exec, -1
    s_branch S_h2r
S_h3:
    s_waitcnt vmcnt(0)
    v_cmpx_lt_i32 vcc, 32, v28
    s_cbranch_execz S_h3_0
    ds_add_rtn_u32 v97, v97, v6 offset:128
    v_cmpx_lt_i32 vcc, 33, v28
    ds_add_rtn_u32 v99, v99, v6 offset:128
    s_mov_b64 exec, -1
    s_waitcnt lgkmcnt(0)
    v_min_u32 v97, 30716, v97
    v_min_u32 v99, 30716, v99
    v_cmpx_lt_i32 vcc, 32, v28
    ds_write_b32 v97, v96
    v_cmpx_lt_i32 vcc, 33, v28
    ds_write_b32 v99, v98
    s_mov_b64 exec, -1
S_h3_0:
    s_mov_b64 exec, -1
    v_cmpx_lt_i32 vcc, 32, v29
    s_cbranch_execz S_h3_1
    ds_add_rtn_u32 v101, v101, v6 offset:128
    v_cmpx_lt_i32 vcc, 33, v29
    ds_add_rtn_u32 v103, v103, v6 offset:128
    s_mov_b64 exec, -1
    s_waitcnt lgkmcnt(0)
    v_min_u32 v101, 30716, v101
    v_min_u32 v103, 30716, v103
    v_cmpx_lt_i32 vcc, 32, v29
    ds_write_b32 v101, v100
    v_cmpx_lt_i32 vcc, 33, v29
    ds_write_b32 v103, v102
    s_mov_b64 exec, -1
S_h3_1:
    s_mov_b64 exec, -1
    v_cmpx_lt_i32 vcc, 32, v30
    s_cbranch_execz S_h3_2
    ds_add_rtn_u32 v105, v105, v6 offset:128
    v_cmpx_lt_i32 vcc, 33, v30
    ds_add_rtn_u32 v107, v107, v6 offset:128
    s_mov_b64 exec, -1
    s_waitcnt lgkmcnt(0)
    v_min_u32 v105, 30716, v105
    v_min_u32 v107, 30716, v107
    v_cmpx_lt_i32 vcc, 32, v30
    ds_write_b32 v105, v104
    v_cmpx_lt_i32 vcc, 33, v30
    ds_write_b32 v107, v106
    s_mov_b64 exec, -1
S_h3_2:
    s_mov_b64 exec, -1
    v_cmpx_lt_i32 vcc, 32, v31
    s_cbranch_execz S_h3_3
    ds_add_rtn_u32 v109, v109, v6 offset:128
    v_cmpx_lt_i32 vcc, 33, v31
    ds_add_rtn_u32 v111, v111, v6 offset:128
    s_mov_b64 exec, -1
    s_waitcnt lgkmcnt(0)
    v_min_u32 v109, 30716, v109
    v_min_u32 v111, 30716, v111
    v_cmpx_lt_i32 vcc, 32, v31
    ds_write_b32 v109, v108
    v_cmpx_lt_i32 vcc, 33, v31
    ds_write_b32 v111, v110
    s_branch K_padC0s
K_padC0:
    s_setpc_b64 s[70:71]
K_padC0s:
    s_mov_b64 exec, -1
S_h3_3:
    s_mov_b64 exec, -1
    v_cmpx_lt_i32 vcc, 32, v32
    s_cbranch_execz S_h3_4
    ds_add_rtn_u32 v113, v113, v6 offset:128
    v_cmpx_lt_i32 vcc, 33, v32
    ds_add_rtn_u32 v115, v115, v6 offset:128
    s_mov_b64 exec, -1
    s_waitcnt lgkmcnt(0)
    v_min_u32 v113, 30716, v113
    v_min_u32 v115, 30716, v115
    v_cmpx_lt_i32 vcc, 32, v32
    ds_write_b32 v113, v112
    v_cmpx_lt_i32 vcc, 33, v32
    ds_write_b32 v115, v114
    s_mov_b64 exec, -1
S_h3_4:
    s_mov_b64 exec, -1
    v_cmpx_lt_i32 vcc, 32, v33
    s_cbranch_execz S_h3_5
    ds_add_rtn_u32 v117, v117, v6 offset:128
    v_cmpx_lt_i32 vcc, 33, v33
    ds_add_rtn_u32 v119, v119, v6 offset:128
    s_mov_b64 exec, -1
    s_waitcnt lgkmcnt(0)
    v_min_u32 v117, 30716, v117
    v_min_u32 v119, 30716, v119
    v_cmpx_lt_i32 vcc, 32, v33
    ds_write_b32 v117, v116
    v_cmpx_lt_i32 vcc, 33, v33
    ds_write_b32 v119, v118
    s_mov_b64 exec, -1
S_h3_5:
    s_mov_b64 exec, -1
    v_cmpx_lt_i32 vcc, 32, v34
    s_cbranch_execz S_h3_6
    ds_add_rtn_u32 v121, v121, v6 offset:128
    v_cmpx_lt_i32 vcc, 33, v34
    ds_add_rtn_u32 v123, v123, v6 offset:128
    s_mov_b64 exec, -1
    s_waitcnt lgkmcnt(0)
    v_min_u32 v121, 30716, v121
    v_min_u32 v123, 30716, v123
    v_cmpx_lt_i32 vcc, 32, v34
    ds_write_b32 v121, v120
    v_cmpx_lt_i32 vcc, 33, v34
    ds_write_b32 v123, v122
    s_mov_b64 exec, -1
S_h3_6:
    s_mov_b64 exec, -1
    v_cmpx_lt_i32 vcc, 32, v35
    s_cbranch_execz S_h3_7
    ds_add_rtn_u32 v125, v125, v6 offset:128
    v_cmpx_lt_i32 vcc, 33, v35
    ds_add_rtn_u32 v127, v127, v6 offset:128
    s_mov_b64 exec, -1
    s_waitcnt lgkmcnt(0)
    v_min_u32 v125, 30716, v125
    v_min_u32 v127, 30716, v127
    v_cmpx_lt_i32 vcc, 32, v35
    ds_write_b32 v125, v124
    v_cmpx_lt_i32 vcc, 33, v35
    ds_write_b32 v127, v126
    s_mov_b64 exec, -1
S_h3_7:
    s_mov_b64 exec, -1
    v_cmp_lt_i32 vcc, 64, v18
    v_add_u32 v17, 512, v17
    v_subrev_u32 v18, 64, v18
    s_mov_b32 s70, 1
    s_cbranch_vccz S_h3r
    s_branch S_rnd
.fill 93, 4, 0xbf800000
K_setup:
    s_setprio 1
    v_mov_b32 v2, v0
    v_mov_b32 v8, 0
    ds_read_b32 v1, v4 offset:24
    v_lshlrev_b32 v13, 3, v2
    v_and_b32 v15, 0x78, v13
    s_mul_i32 s61, s53, 2623488
    s_add_u32 s36, s26, s61
    s_addc_u32 s37, s27, 0
    s_or_b32 s37, s37, 0x1000000
    s_mov_b32 s38, 10248
    s_mov_b32 s39, 0x00020000
    s_add_u32 s46, s52, 158
    s_branch K_padC1s
K_padC1:
    s_setpc_b64 s[70:71]
K_padC1s:
    s_min_u32 s46, s46, 10000
    s_lshl_b32 s46, s46, 9
    s_mov_b64 s[44:45], s[4:5]
    s_mov_b32 s47, 0x00020000
    s_mov_b64 s[48:49], s[22:23]
    s_mov_b32 s50, s46
    s_mov_b32 s51, 0x00020000
    s_lshl_b32 s87, s52, 9
    s_add_u32 s87, s87, s63
    s_mov_b32 s40, 0x0c0c0700
    s_mov_b32 s41, 0x0c0c0600
    s_movk_i32 s42, 260
    s_movk_i32 s43, 16640
    s_andn2_b32 s56, 256, s63
    s_sub_u32 s57, s63, s56
    s_add_u32 s56, s56, 80640
    s_lshl_b32 s61, s54, 2
    s_sub_u32 s66, 3, s55
    s_lshr_b32 s70, 0x5310, s61
    s_and_b32 s70, s70, 15
    s_bitcmp1_b32 0x2aa, s70
    s_cselect_b32 s68, s66, s55
    s_lshl2_add_u32 s70, s70, s68
    s_lshl_b32 s70, s70, 4
    s_lshr_b32 s71, 0x6724, s61
    s_and_b32 s71, s71, 15
    s_bitcmp1_b32 0x2aa, s71
    s_cselect_b32 s68, s66, s55
    s_lshl2_add_u32 s71, s71, s68
    s_lshl_b32 s71, s71, 4
    s_lshr_b32 s72, 0x8999, s61
    s_and_b32 s72, s72, 15
    s_bitcmp1_b32 0x2aa, s72
    s_cselect_b32 s68, s66, s55
    s_lshl2_add_u32 s72, s72, s68
    s_lshl_b32 s72, s72, 4
    v_lshrrev_b32 v3, 4, v2
    v_lshlrev_b32 v3, 2, v3
    v_add_u32 v40, s70, v3
    v_add_u32 v42, s71, v3
    v_add_u32 v44, s72, v3
    v_lshlrev_b32 v97, 1, v15
    s_waitcnt lgkmcnt(0)
    v_readfirstlane_b32 s86, v1
    v_add_u32 v13, s56, v97
    v_mov_b32 v99, v97
    v_mov_b32 v17, v97
    v_mov_b32 v19, v97
    v_mov_b32 v21, v97
    v_mov_b32 v23, v97
    v_mov_b32 v25, v97
    v_mov_b32 v27, v97
    v_mov_b64 v[56:57], 0
    v_mov_b64 v[60:61], 0
    v_mov_b64 v[58:59], 0
    v_mov_b64 v[62:63], 0
    s_mov_b32 s82, 0x358637bd
    s_mov_b32 s83, 0x358637bd
    s_mov_b32 s84, 0x3f80
    s_mov_b32 s85, 0x3f800000
    s_getpc_b64 s[90:91]
K2_pc:
    s_add_u32 s90, s90, K2_flush0-K2_pc
    s_addc_u32 s91, s91, 0
    v_sub_u32 v5, s57, v15
    v_mov_b32 v3, 2384
    s_bitcmp1_b32 s86, 12
    s_cbranch_scc1 K_sd
sp18:
    ds_read_b32 v1, v8 offset:24
    s_sub_u32 s60, s60, 1
    s_cbranch_scc1 K_exit
    s_waitcnt lgkmcnt(0)
    v_readfirstlane_b32 s86, v1
    s_bitcmp1_b32 s86, 12
    s_cbranch_scc1 sp18d
    s_sleep 1
    s_branch sp18
sp18d:
K_sd:
    ds_read_b32 v40, v40 offset:1296
    ds_read_b32 v42, v42 offset:1296
    ds_read_b32 v44, v44 offset:1296
    s_cmp_ge_u32 s86, 65536
    s_cbranch_scc1 K_rare
    s_waitcnt lgkmcnt(2)
    v_readfirstlane_b32 s73, v40
    v_and_b32 v10, 0xffff, v40
    v_mad_u32_u24 v6, v10, 44, v3
    s_add_u32 s73, s73, 262144
    s_lshr_b32 s73, s73, 19
    s_max_u32 s73, s73, 6
    ds_read_u16 v16, v6 offset:0
    ds_read_u16 v18, v6 offset:4
    ds_read_b64 v[100:101], v6 offset:0
    ds_read_u16 v20, v6 offset:8
    ds_read_u16 v22, v6 offset:12
    ds_read_b64 v[102:103], v6 offset:8
    ds_read_u16 v24, v6 offset:16
    ds_read_u16 v26, v6 offset:20
    ds_read_b64 v[104:105], v6 offset:16
    ds_read_u16 v96, v6 offset:24
    ds_read_u16 v98, v6 offset:28
    v_add_u32 v6, 24, v6
    s_waitcnt lgkmcnt(11)
    v_readfirstlane_b32 s74, v42
    v_and_b32 v11, 0xffff, v42
    v_mad_u32_u24 v7, v11, 44, v3
    s_add_u32 s74, s74, 262144
    s_lshr_b32 s74, s74, 19
    s_max_u32 s74, s74, 1
    v_readfirstlane_b32 s75, v44
    v_and_b32 v12, 0xffff, v44
    v_mad_u32_u24 v9, v12, 44, v3
    s_add_u32 s75, s75, 262144
    s_lshr_b32 s75, s75, 19
    s_max_u32 s75, s75, 1
    v_and_b32 v14, 60, v10
    v_mad_u32_u24 v108, v14, s42, v13
    v_lshrrev_b32 v14, 7, v10
    v_subrev_u32 v14, s53, v14
    v_add_u32 v3, 5, v14
    v_min_u32 v14, v14, v3
    v_mad_u32_u24 v108, v14, s43, v108
    v_and_b32 v14, 64, v10
    v_lshl_add_u32 v108, v14, 3, v108
    v_lshl_add_u32 v10, v10, 7, v15
    v_add_u32 v116, v108, v5
    v_and_b32 v14, 60, v11
    v_mad_u32_u24 v109, v14, s42, v13
    v_lshrrev_b32 v14, 7, v11
    v_subrev_u32 v14, s53, v14
    v_add_u32 v3, 5, v14
    v_min_u32 v14, v14, v3
    v_mad_u32_u24 v109, v14, s43, v109
    v_and_b32 v14, 64, v11
    v_lshl_add_u32 v109, v14, 3, v109
    v_lshl_add_u32 v11, v11, 7, v15
    v_add_u32 v118, v109, v5
    v_and_b32 v14, 60, v12
    v_mad_u32_u24 v110, v14, s42, v13
    v_lshrrev_b32 v14, 7, v12
    v_subrev_u32 v14, s53, v14
    v_add_u32 v3, 5, v14
    v_min_u32 v14, v14, v3
    v_mad_u32_u24 v110, v14, s43, v110
    v_and_b32 v14, 64, v12
    v_lshl_add_u32 v110, v14, 3, v110
    v_lshl_add_u32 v12, v12, 7, v15
    v_add_u32 v120, v110, v5
    s_add_u32 s80, s73, s74
    s_add_u32 s81, s80, s75
    s_sub_u32 s73, s73, 1
    s_sub_u32 s74, s74, 1
    s_sub_u32 s75, s75, 1
    s_cmp_lt_u32 s3, 8
    s_cselect_b32 s78, 0x7fff, s75
    s_cselect_b32 s81, s80, s81
    s_cbranch_scc0 K2_three
    v_mov_b32 v9, 2320
K2_three:
    s_sub_u32 s76, s73, 3
    s_mov_b32 s77, s74
    s_sub_i32 s80, s81, 10
    s_max_i32 s80, s80, 0
    s_mov_b32 s72, 1
    s_bitcmp1_b32 s86, 13
    s_waitcnt lgkmcnt(0)
    v_perm_b32 v36, v100, v97, s40
    v_perm_b32 v40, v100, v97, s41
    v_perm_b32 v44, v101, v97, s40
    v_perm_b32 v48, v101, v97, s41
    s_cbranch_scc1 K_gl
sp19:
    ds_read_b32 v1, v8 offset:24
    s_sub_u32 s60, s60, 1
    s_cbranch_scc1 K_exit
    s_waitcnt lgkmcnt(0)
    v_readfirstlane_b32 s86, v1
    s_bitcmp1_b32 s86, 13
    s_cbranch_scc1 sp19d
    s_sleep 1
    s_branch sp19
sp19d:
K_gl:
    s_setprio 3
    buffer_load_dwordx4 v[64:67], v[16:17], s[36:39], 0 idxen offen sc1
    buffer_load_dwordx4 v[68:71], v[18:19], s[36:39], 0 idxen offen sc1
    buffer_load_dwordx4 v[72:75], v[20:21], s[36:39], 0 idxen offen sc1
    buffer_load_dwordx4 v[76:79], v[22:23], s[36:39], 0 idxen offen sc1
    buffer_load_dwordx4 v[80:83], v[24:25], s[36:39], 0 idxen offen sc1
    buffer_load_dwordx4 v[84:87], v[26:27], s[36:39], 0 idxen offen sc1
    s_bitcmp1_b32 s86, 4
    s_cbranch_scc1 K_loc
sp20:
    ds_read_b32 v1, v8 offset:24
    s_sub_u32 s60, s60, 1
    s_cbranch_scc1 K_exit
    s_waitcnt lgkmcnt(0)
    v_readfirstlane_b32 s86, v1
    s_bitcmp1_b32 s86, 4
    s_cbranch_scc1 sp20d
    s_sleep 1
    s_branch sp20
sp20d:
K_loc:
    ds_read_b128 v[52:55], v108
    ds_read_b128 v[36:39], v36 offset:15104
    ds_read_b128 v[40:43], v40 offset:15104
    ds_read_b128 v[44:47], v44 offset:15104
    ds_read_b128 v[48:51], v48 offset:15104
    ds_read_b64 v[116:117], v116
    ds_read_b64 v[118:119], v118
    ds_read_b64 v[120:121], v120
    s_cmp_ge_u32 s86, 65536
    s_cbranch_scc1 K_rare
    s_branch K2_loop
K_padC2:
    s_setpc_b64 s[70:71]
.fill 2, 4, 0xbf800000
K2_loop:
    s_waitcnt vmcnt(4) lgkmcnt(0)
    v_pk_mul_f32 v[16:17], v[36:37], v[64:65]
    v_pk_mul_f32 v[18:19], v[38:39], v[66:67]
    v_pk_mul_f32 v[20:21], v[44:45], v[68:69]
    v_pk_mul_f32 v[22:23], v[46:47], v[70:71]
    v_lshlrev_b64 v[24:25], 16, v[64:65]
    v_lshlrev_b64 v[28:29], 16, v[68:69]
    v_lshlrev_b64 v[26:27], 16, v[66:67]
    v_lshlrev_b64 v[30:31], 16, v[70:71]
    buffer_load_dwordx4 v[64:67], v[96:97], s[36:39], 0 idxen offen sc1
    buffer_load_dwordx4 v[68:71], v[98:99], s[36:39], 0 idxen offen sc1
    v_pk_fma_f32 v[16:17], v[16:17], v[40:41], v[52:53]
    v_pk_fma_f32 v[18:19], v[18:19], v[42:43], v[54:55]
    v_pk_fma_f32 v[20:21], v[20:21], v[48:49], v[52:53]
    v_pk_fma_f32 v[22:23], v[22:23], v[50:51], v[54:55]
    v_perm_b32 v36, v102, v97, s40
    v_perm_b32 v40, v102, v97, s41
    v_perm_b32 v44, v103, v97, s40
    v_perm_b32 v48, v103, v97, s41
    ds_read_b128 v[36:39], v36 offset:15104
    ds_read_b128 v[40:43], v40 offset:15104
    ds_read_b128 v[44:47], v44 offset:15104
    ds_read_b128 v[48:51], v48 offset:15104
    ds_read_b64 v[100:101], v6 offset:0
    s_sub_u32 s76, s76, 1
    s_cbranch_scc1 K2_sw_0
K2_swr_0:
    ds_read_u16 v96, v6 offset:8
    ds_read_u16 v98, v6 offset:12
    v_pk_mul_f32 v[32:33], v[16:17], v[20:21]
    v_pk_mul_f32 v[34:35], v[18:19], v[22:23]
    v_rcp_f32 v32, v32
    v_rcp_f32 v33, v33
    v_rcp_f32 v34, v34
    v_rcp_f32 v35, v35
    v_pk_mul_f32 v[24:25], v[20:21], v[24:25]
    v_pk_mul_f32 v[26:27], v[22:23], v[26:27]
    v_pk_fma_f32 v[24:25], v[16:17], v[28:29], v[24:25]
    v_pk_fma_f32 v[26:27], v[18:19], v[30:31], v[26:27]
    v_pk_add_f32 v[16:17], v[16:17], v[20:21]
    v_pk_add_f32 v[18:19], v[18:19], v[22:23]
    v_pk_fma_f32 v[60:61], v[32:33], v[24:25], v[60:61]
    v_pk_fma_f32 v[62:63], v[34:35], v[26:27], v[62:63]
    s_sub_u32 s73, s73, 1
    v_pk_fma_f32 v[56:57], v[32:33], v[16:17], v[56:57]
    v_pk_fma_f32 v[58:59], v[34:35], v[18:19], v[58:59]
    s_cbranch_scc1 K2_fs_0
K2_flr_0:
    s_waitcnt vmcnt(4) lgkmcnt(0)
    v_pk_mul_f32 v[16:17], v[36:37], v[72:73]
    v_pk_mul_f32 v[18:19], v[38:39], v[74:75]
    v_pk_mul_f32 v[20:21], v[44:45], v[76:77]
    v_pk_mul_f32 v[22:23], v[46:47], v[78:79]
    v_lshlrev_b64 v[24:25], 16, v[72:73]
    v_lshlrev_b64 v[28:29], 16, v[76:77]
    v_lshlrev_b64 v[26:27], 16, v[74:75]
    v_lshlrev_b64 v[30:31], 16, v[78:79]
    buffer_load_dwordx4 v[72:75], v[96:97], s[36:39], 0 idxen offen sc1
    buffer_load_dwordx4 v[76:79], v[98:99], s[36:39], 0 idxen offen sc1
    v_pk_fma_f32 v[16:17], v[16:17], v[40:41], v[52:53]
    v_pk_fma_f32 v[18:19], v[18:19], v[42:43], v[54:55]
    v_pk_fma_f32 v[20:21], v[20:21], v[48:49], v[52:53]
    v_pk_fma_f32 v[22:23], v[22:23], v[50:51], v[54:55]
    v_perm_b32 v36, v104, v97, s40
    v_perm_b32 v40, v104, v97, s41
    v_perm_b32 v44, v105, v97, s40
    v_perm_b32 v48, v105, v97, s41
    ds_read_b128 v[36:39], v36 offset:15104
    ds_read_b128 v[40:43], v40 offset:15104
    ds_read_b128 v[44:47], v44 offset:15104
    ds_read_b128 v[48:51], v48 offset:15104
    ds_read_b64 v[102:103], v6 offset:8
    s_sub_u32 s76, s76, 1
    s_cbranch_scc1 K2_sw_1
K2_swr_1:
    ds_read_u16 v96, v6 offset:16
    ds_read_u16 v98, v6 offset:20
    v_pk_mul_f32 v[32:33], v[16:17], v[20:21]
    v_pk_mul_f32 v[34:35], v[18:19], v[22:23]
    v_rcp_f32 v32, v32
    v_rcp_f32 v33, v33
    v_rcp_f32 v34, v34
    v_rcp_f32 v35, v35
    v_pk_mul_f32 v[24:25], v[20:21], v[24:25]
    v_pk_mul_f32 v[26:27], v[22:23], v[26:27]
    v_pk_fma_f32 v[24:25], v[16:17], v[28:29], v[24:25]
    v_pk_fma_f32 v[26:27], v[18:19], v[30:31], v[26:27]
    v_pk_add_f32 v[16:17], v[16:17], v[20:21]
    v_pk_add_f32 v[18:19], v[18:19], v[22:23]
    v_pk_fma_f32 v[60:61], v[32:33], v[24:25], v[60:61]
    v_pk_fma_f32 v[62:63], v[34:35], v[26:27], v[62:63]
    s_sub_u32 s73, s73, 1
    v_pk_fma_f32 v[56:57], v[32:33], v[16:17], v[56:57]
    v_pk_fma_f32 v[58:59], v[34:35], v[18:19], v[58:59]
    s_cbranch_scc1 K2_fs_1
K2_flr_1:
    s_waitcnt vmcnt(4) lgkmcnt(0)
    v_pk_mul_f32 v[16:17], v[36:37], v[80:81]
    v_pk_mul_f32 v[18:19], v[38:39], v[82:83]
    v_pk_mul_f32 v[20:21], v[44:45], v[84:85]
    v_pk_mul_f32 v[22:23], v[46:47], v[86:87]
    v_lshlrev_b64 v[24:25], 16, v[80:81]
    v_lshlrev_b64 v[28:29], 16, v[84:85]
    v_lshlrev_b64 v[26:27], 16, v[82:83]
    v_lshlrev_b64 v[30:31], 16, v[86:87]
    buffer_load_dwordx4 v[80:83], v[96:97], s[36:39], 0 idxen offen sc1
    buffer_load_dwordx4 v[84:87], v[98:99], s[36:39], 0 idxen offen sc1
    v_pk_fma_f32 v[16:17], v[16:17], v[40:41], v[52:53]
    v_pk_fma_f32 v[18:19], v[18:19], v[42:43], v[54:55]
    v_pk_fma_f32 v[20:21], v[20:21], v[48:49], v[52:53]
    v_pk_fma_f32 v[22:23], v[22:23], v[50:51], v[54:55]
    v_perm_b32 v36, v100, v97, s40
    v_perm_b32 v40, v100, v97, s41
    v_perm_b32 v44, v101, v97, s40
    v_perm_b32 v48, v101, v97, s41
    ds_read_b128 v[36:39], v36 offset:15104
    ds_read_b128 v[40:43], v40 offset:15104
    ds_read_b128 v[44:47], v44 offset:15104
    ds_read_b128 v[48:51], v48 offset:15104
    ds_read_b64 v[104:105], v6 offset:16
    s_sub_u32 s76, s76, 1
    s_cbranch_scc1 K2_sw_2
K2_swr_2:
    ds_read_u16 v96, v6 offset:24
    ds_read_u16 v98, v6 offset:28
    v_add_u32 v6, 24, v6
    v_pk_mul_f32 v[32:33], v[16:17], v[20:21]
    v_pk_mul_f32 v[34:35], v[18:19], v[22:23]
    v_rcp_f32 v32, v32
    v_rcp_f32 v33, v33
    v_rcp_f32 v34, v34
    v_rcp_f32 v35, v35
    v_pk_mul_f32 v[24:25], v[20:21], v[24:25]
    v_pk_mul_f32 v[26:27], v[22:23], v[26:27]
    v_pk_fma_f32 v[24:25], v[16:17], v[28:29], v[24:25]
    v_pk_fma_f32 v[26:27], v[18:19], v[30:31], v[26:27]
    v_pk_add_f32 v[16:17], v[16:17], v[20:21]
    v_pk_add_f32 v[18:19], v[18:19], v[22:23]
    v_pk_fma_f32 v[60:61], v[32:33], v[24:25], v[60:61]
    v_pk_fma_f32 v[62:63], v[34:35], v[26:27], v[62:63]
    s_sub_u32 s73, s73, 1
    v_pk_fma_f32 v[56:57], v[32:33], v[16:17], v[56:57]
    v_pk_fma_f32 v[58:59], v[34:35], v[18:19], v[58:59]
    s_cbranch_scc1 K2_fs_2
K2_flr_2:
    s_sub_u32 s80, s80, 3
    s_cbranch_scc0 K2_loop
    s_add_u32 s72, s72, 1
    s_setprio 2
    s_movk_i32 s80, 2
    s_cmp_eq_u32 s72, 2
    s_cbranch_scc1 K2_loop
    s_setprio 1
    s_movk_i32 s80, 2
    s_cmp_eq_u32 s72, 3
    s_cbranch_scc1 K2_loop
    s_setprio 0
    s_movk_i32 s80, 0x7fff
    s_branch K2_loop
K_padC3:
    s_setpc_b64 s[70:71]
K2_sw_0:
    v_subrev_u32 v6, 8, v7
    v_mov_b32 v7, v9
    v_mov_b32 v9, 2320
    s_mov_b32 s76, s77
    s_mov_b32 s77, s78
    s_movk_i32 s78, 0x7fff
    s_branch K2_swr_0
K2_fs_0:
    s_swappc_b64 s[88:89], s[90:91]
    s_branch K2_flr_0
K2_sw_1:
    v_subrev_u32 v6, 16, v7
    v_mov_b32 v7, v9
    v_mov_b32 v9, 2320
    s_mov_b32 s76, s77
    s_mov_b32 s77, s78
    s_movk_i32 s78, 0x7fff
    s_branch K2_swr_1
K2_fs_1:
    s_swappc_b64 s[88:89], s[90:91]
    s_branch K2_flr_1
K2_sw_2:
    v_subrev_u32 v6, 24, v7
    v_mov_b32 v7, v9
    v_mov_b32 v9, 2320
    s_mov_b32 s76, s77
    s_mov_b32 s77, s78
    s_movk_i32 s78, 0x7fff
    s_branch K2_swr_2
K2_fs_2:
    s_swappc_b64 s[88:89], s[90:91]
    s_branch K2_flr_2
K2_flush0:
    v_pk_fma_f32 v[56:57], v[56:57], v[52:53], s[82:83]
    v_pk_fma_f32 v[58:59], v[58:59], v[54:55], s[82:83]
    v_pk_mul_f32 v[60:61], v[60:61], v[52:53]
    v_pk_mul_f32 v[62:63], v[62:63], v[54:55]
    v_lshlrev_b64 v[24:25], 16, v[52:53]
    v_lshlrev_b64 v[26:27], 16, v[54:55]
    ds_read_b128 v[52:55], v109
    v_rcp_f32 v56, v56
    v_rcp_f32 v57, v57
    v_rcp_f32 v58, v58
    v_rcp_f32 v59, v59
    s_mov_b32 s73, s74
    v_pk_fma_f32 v[24:25], v[60:61], v[56:57], v[24:25]
    v_pk_fma_f32 v[26:27], v[62:63], v[58:59], v[26:27]
    v_pk_mul_f32 v[32:33], v[24:25], 0 op_sel_hi:[1,0]
    v_pk_fma_f32 v[32:33], v[26:27], 0, v[32:33] op_sel_hi:[1,0,1]
    v_max_f32 v24, 0, v24
    v_max_f32 v25, 0, v25
    v_max_f32 v26, 0, v26
    v_max_f32 v27, 0, v27
    v_cmp_u_f32 vcc, v32, v33
    v_dot2_f32_bf16 v24, v116, s84, v24
    v_dot2_f32_bf16 v25, v116, s85, v25
    v_dot2_f32_bf16 v26, v117, s84, v26
    v_dot2_f32_bf16 v27, v117, s85, v27
    v_mov_b64 v[56:57], 0
    v_mov_b64 v[60:61], 0
    v_mov_b64 v[58:59], 0
    v_mov_b64 v[62:63], 0
    v_cvt_pk_bf16_f32 v28, v24, v25
    v_cvt_pk_bf16_f32 v29, v26, v27
    s_cbranch_vccnz K2_slow_local
    buffer_store_dwordx2 v[28:29], v10, s[48:51], s87 offen sc1
    s_add_u32 s90, s90, K2_flush1-K2_flush0
    s_addc_u32 s91, s91, 0
    s_setpc_b64 s[88:89]
K2_flush1:
    v_pk_fma_f32 v[56:57], v[56:57], v[52:53], s[82:83]
    v_pk_fma_f32 v[58:59], v[58:59], v[54:55], s[82:83]
    v_pk_mul_f32 v[60:61], v[60:61], v[52:53]
    v_pk_mul_f32 v[62:63], v[62:63], v[54:55]
    v_lshlrev_b64 v[24:25], 16, v[52:53]
    v_lshlrev_b64 v[26:27], 16, v[54:55]
    ds_read_b128 v[52:55], v110
    v_rcp_f32 v56, v56
    v_rcp_f32 v57, v57
    v_rcp_f32 v58, v58
    v_rcp_f32 v59, v59
    s_mov_b32 s73, s75
    v_pk_fma_f32 v[24:25], v[60:61], v[56:57], v[24:25]
    v_pk_fma_f32 v[26:27], v[62:63], v[58:59], v[26:27]
    v_pk_mul_f32 v[32:33], v[24:25], 0 op_sel_hi:[1,0]
    v_pk_fma_f32 v[32:33], v[26:27], 0, v[32:33] op_sel_hi:[1,0,1]
    v_max_f32 v24, 0, v24
    v_max_f32 v25, 0, v25
    v_max_f32 v26, 0, v26
    v_max_f32 v27, 0, v27
    v_cmp_u_f32 vcc, v32, v33
    v_dot2_f32_bf16 v24, v118, s84, v24
    v_dot2_f32_bf16 v25, v118, s85, v25
    v_dot2_f32_bf16 v26, v119, s84, v26
    v_dot2_f32_bf16 v27, v119, s85, v27
    v_mov_b64 v[56:57], 0
    v_mov_b64 v[60:61], 0
    v_mov_b64 v[58:59], 0
    v_mov_b64 v[62:63], 0
    v_cvt_pk_bf16_f32 v28, v24, v25
    v_cvt_pk_bf16_f32 v29, v26, v27
    s_cbranch_vccnz K2_slow_local
    buffer_store_dwordx2 v[28:29], v11, s[48:51], s87 offen sc1
    s_cmp_lt_u32 s3, 8
    s_cbranch_scc1 K2_end
    s_add_u32 s90, s90, K2_flush2-K2_flush1
    s_addc_u32 s91, s91, 0
    s_setpc_b64 s[88:89]
K2_flush2:
    v_pk_fma_f32 v[56:57], v[56:57], v[52:53], s[82:83]
    v_pk_fma_f32 v[58:59], v[58:59], v[54:55], s[82:83]
    v_pk_mul_f32 v[60:61], v[60:61], v[52:53]
    v_pk_mul_f32 v[62:63], v[62:63], v[54:55]
    v_lshlrev_b64 v[24:25], 16, v[52:53]
    v_lshlrev_b64 v[26:27], 16, v[54:55]
    v_rcp_f32 v56, v56
    v_rcp_f32 v57, v57
    v_rcp_f32 v58, v58
    v_rcp_f32 v59, v59
    s_nop 0
    v_pk_fma_f32 v[24:25], v[60:61], v[56:57], v[24:25]
    v_pk_fma_f32 v[26:27], v[62:63], v[58:59], v[26:27]
    v_pk_mul_f32 v[32:33], v[24:25], 0 op_sel_hi:[1,0]
    v_pk_fma_f32 v[32:33], v[26:27], 0, v[32:33] op_sel_hi:[1,0,1]
    v_max_f32 v24, 0, v24
    v_max_f32 v25, 0, v25
    v_max_f32 v26, 0, v26
    v_max_f32 v27, 0, v27
    v_cmp_u_f32 vcc, v32, v33
    v_dot2_f32_bf16 v24, v120, s84, v24
    v_dot2_f32_bf16 v25, v120, s85, v25
    v_dot2_f32_bf16 v26, v121, s84, v26
    v_dot2_f32_bf16 v27, v121, s85, v27
    s_nop 2
    v_cvt_pk_bf16_f32 v28, v24, v25
    v_cvt_pk_bf16_f32 v29, v26, v27
    s_cbranch_vccnz K2_slow_local
    buffer_store_dwordx2 v[28:29], v12, s[48:51], s87 offen sc1
K2_end:
K_exit:
    s_endpgm
K_finto:
    s_mov_b64 exec, 1
    v_mov_b32 v1, 0x80002000
    ds_or_b32 v4, v1 offset:24
    s_mov_b64 exec, -1
    s_waitcnt vmcnt(0)
    s_branch K_setup
P_raw:
    s_mov_b32 s70, 0x10001
    s_mov_b32 s61, 0x3fffffff
    v_exp_f32 v12, v16
    v_cvt_pk_bf16_f32 v13, v24, v16
    v_and_b32 v14, 0x7fffffff, v16
    v_cmp_nge_f32 vcc, 0x41e00000, v14
    v_cvt_pk_bf16_f32 v16, v24, v12
    v_lshrrev_b32 v14, 1, v13
    v_or_b32 v14, 0x80000000, v14
    v_bfi_b32 v13, s61, v13, v14
    v_cndmask_b32 v16, v16, v13, vcc
    v_exp_f32 v12, v17
    v_cvt_pk_bf16_f32 v13, v25, v17
    v_and_b32 v14, 0x7fffffff, v17
    v_cmp_nge_f32 vcc, 0x41e00000, v14
    v_cvt_pk_bf16_f32 v17, v25, v12
    v_lshrrev_b32 v14, 1, v13
    v_or_b32 v14, 0x80000000, v14
    v_bfi_b32 v13, s61, v13, v14
    v_cndmask_b32 v17, v17, v13, vcc
    v_exp_f32 v12, v18
    v_cvt_pk_bf16_f32 v13, v26, v18
    v_and_b32 v14, 0x7fffffff, v18
    v_cmp_nge_f32 vcc, 0x41e00000, v14
    v_cvt_pk_bf16_f32 v18, v26, v12
    v_lshrrev_b32 v14, 1, v13
    v_or_b32 v14, 0x80000000, v14
    v_bfi_b32 v13, s61, v13, v14
    v_cndmask_b32 v18, v18, v13, vcc
    v_exp_f32 v12, v19
    v_cvt_pk_bf16_f32 v13, v27, v19
    v_and_b32 v14, 0x7fffffff, v19
    v_cmp_nge_f32 vcc, 0x41e00000, v14
    v_cvt_pk_bf16_f32 v19, v27, v12
    v_lshrrev_b32 v14, 1, v13
    v_or_b32 v14, 0x80000000, v14
    v_bfi_b32 v13, s61, v13, v14
    v_cndmask_b32 v19, v19, v13, vcc
    s_mov_b32 s61, 0x3fffffff
    v_exp_f32 v12, v20
    v_cvt_pk_bf16_f32 v13, v28, v20
    v_and_b32 v14, 0x7fffffff, v20
    v_cmp_nge_f32 vcc, 0x41e00000, v14
    v_cvt_pk_bf16_f32 v20, v28, v12
    v_lshrrev_b32 v14, 1, v13
    v_or_b32 v14, 0x80000000, v14
    v_bfi_b32 v13, s61, v13, v14
    v_cndmask_b32 v20, v20, v13, vcc
    v_exp_f32 v12, v21
    v_cvt_pk_bf16_f32 v13, v29, v21
    v_and_b32 v14, 0x7fffffff, v21
    v_cmp_nge_f32 vcc, 0x41e00000, v14
    v_cvt_pk_bf16_f32 v21, v29, v12
    v_lshrrev_b32 v14, 1, v13
    v_or_b32 v14, 0x80000000, v14
    v_bfi_b32 v13, s61, v13, v14
    v_cndmask_b32 v21, v21, v13, vcc
    v_exp_f32 v12, v22
    v_cvt_pk_bf16_f32 v13, v30, v22
    v_and_b32 v14, 0x7fffffff, v22
    v_cmp_nge_f32 vcc, 0x41e00000, v14
    v_cvt_pk_bf16_f32 v22, v30, v12
    v_lshrrev_b32 v14, 1, v13
    v_or_b32 v14, 0x80000000, v14
    v_bfi_b32 v13, s61, v13, v14
    v_cndmask_b32 v22, v22, v13, vcc
    v_exp_f32 v12, v23
    v_cvt_pk_bf16_f32 v13, v31, v23
    v_and_b32 v14, 0x7fffffff, v23
    v_cmp_nge_f32 vcc, 0x41e00000, v14
    v_cvt_pk_bf16_f32 v23, v31, v12
    v_lshrrev_b32 v14, 1, v13
    v_or_b32 v14, 0x80000000, v14
    v_bfi_b32 v13, s61, v13, v14
    v_cndmask_b32 v23, v23, v13, vcc
    s_branch P_rawr
U_raw:
    s_mov_b32 s70, 65537
    s_mov_b32 s61, 0x3fffffff
    v_exp_f32 v7, v16
    v_cvt_pk_bf16_f32 v8, v24, v16
    v_and_b32 v9, 0x7fffffff, v16
    v_cmp_nge_f32 vcc, 0x41e00000, v9
    v_cvt_pk_bf16_f32 v16, v24, v7
    v_lshrrev_b32 v9, 1, v8
    v_or_b32 v9, 0x80000000, v9
    v_bfi_b32 v8, s61, v8, v9
    v_cndmask_b32 v16, v16, v8, vcc
    v_exp_f32 v7, v17
    v_cvt_pk_bf16_f32 v8, v25, v17
    v_and_b32 v9, 0x7fffffff, v17
    v_cmp_nge_f32 vcc, 0x41e00000, v9
    v_cvt_pk_bf16_f32 v17, v25, v7
    v_lshrrev_b32 v9, 1, v8
    v_or_b32 v9, 0x80000000, v9
    v_bfi_b32 v8, s61, v8, v9
    v_cndmask_b32 v17, v17, v8, vcc
    v_exp_f32 v7, v18
    v_cvt_pk_bf16_f32 v8, v26, v18
    v_and_b32 v9, 0x7fffffff, v18
    v_cmp_nge_f32 vcc, 0x41e00000, v9
    v_cvt_pk_bf16_f32 v18, v26, v7
    v_lshrrev_b32 v9, 1, v8
    v_or_b32 v9, 0x80000000, v9
    v_bfi_b32 v8, s61, v8, v9
    v_cndmask_b32 v18, v18, v8, vcc
    v_exp_f32 v7, v19
    v_cvt_pk_bf16_f32 v8, v27, v19
    v_and_b32 v9, 0x7fffffff, v19
    v_cmp_nge_f32 vcc, 0x41e00000, v9
    v_cvt_pk_bf16_f32 v19, v27, v7
    v_lshrrev_b32 v9, 1, v8
    v_or_b32 v9, 0x80000000, v9
    v_bfi_b32 v8, s61, v8, v9
    v_cndmask_b32 v19, v19, v8, vcc
    s_mov_b32 s61, 0x3fffffff
    v_exp_f32 v7, v20
    v_cvt_pk_bf16_f32 v8, v28, v20
    v_and_b32 v9, 0x7fffffff, v20
    v_cmp_nge_f32 vcc, 0x41e00000, v9
    v_cvt_pk_bf16_f32 v20, v28, v7
    v_lshrrev_b32 v9, 1, v8
    v_or_b32 v9, 0x80000000, v9
    v_bfi_b32 v8, s61, v8, v9
    v_cndmask_b32 v20, v20, v8, vcc
    v_exp_f32 v7, v21
    v_cvt_pk_bf16_f32 v8, v29, v21
    v_and_b32 v9, 0x7fffffff, v21
    v_cmp_nge_f32 vcc, 0x41e00000, v9
    v_cvt_pk_bf16_f32 v21, v29, v7
    v_lshrrev_b32 v9, 1, v8
    v_or_b32 v9, 0x80000000, v9
    v_bfi_b32 v8, s61, v8, v9
    v_cndmask_b32 v21, v21, v8, vcc
    v_exp_f32 v7, v22
    v_cvt_pk_bf16_f32 v8, v30, v22
    v_and_b32 v9, 0x7fffffff, v22
    v_cmp_nge_f32 vcc, 0x41e00000, v9
    v_cvt_pk_bf16_f32 v22, v30, v7
    v_lshrrev_b32 v9, 1, v8
    v_or_b32 v9, 0x80000000, v9
    v_bfi_b32 v8, s61, v8, v9
    v_cndmask_b32 v22, v22, v8, vcc
    v_exp_f32 v7, v23
    v_cvt_pk_bf16_f32 v8, v31, v23
    v_and_b32 v9, 0x7fffffff, v23
    v_cmp_nge_f32 vcc, 0x41e00000, v9
    v_cvt_pk_bf16_f32 v23, v31, v7
    v_lshrrev_b32 v9, 1, v8
    v_or_b32 v9, 0x80000000, v9
    v_bfi_b32 v8, s61, v8, v9
    v_cndmask_b32 v23, v23, v8, vcc
    s_branch U_rawr
K_rare:
sp21:
    ds_read_b32 v1, v8 offset:24
    s_sub_u32 s60, s60, 1
    s_cbranch_scc1 K_exit
    s_waitcnt lgkmcnt(0)
    v_readfirstlane_b32 s86, v1
    s_bitcmp1_b32 s86, 12
    s_cbranch_scc1 sp21d
    s_sleep 1
    s_branch sp21
sp21d:
sp22:
    ds_read_b32 v1, v8 offset:24
    s_sub_u32 s60, s60, 1
    s_cbranch_scc1 K_exit
    s_waitcnt lgkmcnt(0)
    v_readfirstlane_b32 s86, v1
    s_bitcmp1_b32 s86, 13
    s_cbranch_scc1 sp22d
    s_sleep 1
    s_branch sp22
sp22d:
sp23:
    ds_read_b32 v1, v8 offset:24
    s_sub_u32 s60, s60, 1
    s_cbranch_scc1 K_exit
    s_waitcnt lgkmcnt(0)
    v_readfirstlane_b32 s86, v1
    s_bitcmp1_b32 s86, 4
    s_cbranch_scc1 sp23d
    s_sleep 1
    s_branch sp23
sp23d:
    s_bitcmp1_b32 s86, 31
    s_cbranch_scc0 K2_slow
    s_load_dwordx16 s[4:19], s[0:1], 0
    s_load_dwordx8 s[20:27], s[0:1], 64
    s_waitcnt vmcnt(0) lgkmcnt(0)
    s_mov_b32 s64, s14
    s_mov_b32 s65, s15
    s_mov_b32 s66, 0x20000
    s_mov_b32 s67, 0x00020000
    s_mov_b32 s68, s20
    s_mov_b32 s69, s21
    s_mov_b32 s70, 0x20000
    s_mov_b32 s71, 0x00020000
    s_mov_b32 s28, s4
    s_mov_b32 s29, s5
    s_mov_b32 s30, 0x4e2000
    s_mov_b32 s31, 0x00020000
    s_mov_b32 s76, 0xbfb8aa3b
    s_lshl_b32 s77, s55, 5
    s_add_u32 s77, s77, s63
    s_lshl_b32 s75, s55, 6
    s_mul_i32 s61, s53, 2623488
    s_add_u32 s75, s75, s61
    s_add_u32 s75, s75, 33554432
    v_and_b32 v16, 15, v2
    v_lshrrev_b32 v17, 4, v2
    v_lshlrev_b32 v18, 12, v17
    v_lshl_add_u32 v18, v16, 1, v18
    v_lshlrev_b32 v19, 4, v17
    v_lshl_add_u32 v20, v16, 8, v19
    v_lshl_add_u32 v19, v16, 9, v19
    s_mov_b32 s74, s54
O_tile:
    v_mov_b32 v64, 0
    v_mov_b32 v65, 0
    v_mov_b32 v66, 0
    v_mov_b32 v67, 0
    v_mov_b32 v68, 0
    v_mov_b32 v69, 0
    v_mov_b32 v70, 0
    v_mov_b32 v71, 0
    s_lshl_b32 s78, s74, 13
    s_mov_b32 s79, s77
O_k:
    buffer_load_dwordx4 v[24:27], v19, s[28:31], s78 offen
    buffer_load_ushort v28, v18, s[64:67], s79 offen offset:0
    buffer_load_ushort v29, v18, s[64:67], s79 offen offset:512
    buffer_load_ushort v30, v18, s[64:67], s79 offen offset:1024
    buffer_load_ushort v31, v18, s[64:67], s79 offen offset:1536
    buffer_load_ushort v32, v18, s[64:67], s79 offen offset:2048
    buffer_load_ushort v33, v18, s[64:67], s79 offen offset:2560
    buffer_load_ushort v34, v18, s[64:67], s79 offen offset:3072
    buffer_load_ushort v35, v18, s[64:67], s79 offen offset:3584
    buffer_load_ushort v36, v18, s[68:71], s79 offen offset:0
    buffer_load_ushort v37, v18, s[68:71], s79 offen offset:512
    buffer_load_ushort v38, v18, s[68:71], s79 offen offset:1024
    buffer_load_ushort v39, v18, s[68:71], s79 offen offset:1536
    buffer_load_ushort v40, v18, s[68:71], s79 offen offset:2048
    buffer_load_ushort v41, v18, s[68:71], s79 offen offset:2560
    buffer_load_ushort v42, v18, s[68:71], s79 offen offset:3072
    buffer_load_ushort v43, v18, s[68:71], s79 offen offset:3584
    s_waitcnt vmcnt(0)
    v_lshl_or_b32 v72, v29, 16, v28
    v_lshl_or_b32 v73, v31, 16, v30
    v_lshl_or_b32 v74, v33, 16, v32
    v_lshl_or_b32 v75, v35, 16, v34
    v_lshl_or_b32 v76, v37, 16, v36
    v_lshl_or_b32 v77, v39, 16, v38
    v_lshl_or_b32 v78, v41, 16, v40
    v_lshl_or_b32 v79, v43, 16, v42
    s_nop 1
    v_mfma_f32_16x16x32_bf16 v[64:67], v[72:75], v[24:27], v[64:67]
    v_mfma_f32_16x16x32_bf16 v[68:71], v[76:79], v[24:27], v[68:71]
    s_add_u32 s78, s78, 64
    s_add_u32 s79, s79, 16384
    s_cmp_lt_u32 s79, 0x20000
    s_nop 7
    s_cbranch_scc1 O_k
    v_mul_f32 v64, s76, v64
    v_mul_f32 v65, s76, v65
    v_mul_f32 v66, s76, v66
    v_mul_f32 v67, s76, v67
    s_mov_b32 s61, 0x3fffffff
    v_exp_f32 v28, v64
    v_cvt_pk_bf16_f32 v29, v68, v64
    v_and_b32 v30, 0x7fffffff, v64
    v_cmp_nge_f32 vcc, 0x41e00000, v30
    v_cvt_pk_bf16_f32 v72, v68, v28
    v_lshrrev_b32 v30, 1, v29
    v_or_b32 v30, 0x80000000, v30
    v_bfi_b32 v29, s61, v29, v30
    v_cndmask_b32 v72, v72, v29, vcc
    v_exp_f32 v28, v65
    v_cvt_pk_bf16_f32 v29, v69, v65
    v_and_b32 v30, 0x7fffffff, v65
    v_cmp_nge_f32 vcc, 0x41e00000, v30
    v_cvt_pk_bf16_f32 v73, v69, v28
    v_lshrrev_b32 v30, 1, v29
    v_or_b32 v30, 0x80000000, v30
    v_bfi_b32 v29, s61, v29, v30
    v_cndmask_b32 v73, v73, v29, vcc
    v_exp_f32 v28, v66
    v_cvt_pk_bf16_f32 v29, v70, v66
    v_and_b32 v30, 0x7fffffff, v66
    v_cmp_nge_f32 vcc, 0x41e00000, v30
    v_cvt_pk_bf16_f32 v74, v70, v28
    v_lshrrev_b32 v30, 1, v29
    v_or_b32 v30, 0x80000000, v30
    v_bfi_b32 v29, s61, v29, v30
    v_cndmask_b32 v74, v74, v29, vcc
    v_exp_f32 v28, v67
    v_cvt_pk_bf16_f32 v29, v71, v67
    v_and_b32 v30, 0x7fffffff, v67
    v_cmp_nge_f32 vcc, 0x41e00000, v30
    v_cvt_pk_bf16_f32 v75, v71, v28
    v_lshrrev_b32 v30, 1, v29
    v_or_b32 v30, 0x80000000, v30
    v_bfi_b32 v29, s61, v29, v30
    v_cndmask_b32 v75, v75, v29, vcc
    s_lshl_b32 s78, s74, 12
    s_add_u32 s78, s78, s75
    buffer_store_dwordx4 v[72:75], v20, s[32:35], s78 offen sc1
    s_add_u32 s74, s74, 4
    s_cmp_lt_u32 s74, 625
    s_cbranch_scc1 O_tile
    s_waitcnt vmcnt(0)
    s_barrier
    s_add_u32 s36, s36, 33554432
    s_addc_u32 s37, s37, 0
K2_slow:
    v_lshrrev_b32 v1, 4, v2
    s_sub_u32 s61, 15, s3
    s_lshl_b32 s61, s61, 2
    v_add_u32 v1, s61, v1
    v_add_u32 v10, 0, v1
    v_lshl_add_u32 v10, v10, 9, v15
    v_add_u32 v11, 64, v1
    v_lshl_add_u32 v11, v11, 9, v15
    v_add_u32 v12, 128, v1
    v_lshl_add_u32 v12, v12, 9, v15
K2_slow_local:
    s_waitcnt lgkmcnt(0)
    s_load_dwordx16 s[4:19], s[0:1], 0
    s_waitcnt vmcnt(0) lgkmcnt(0)
    s_mov_b32 s28, s16
    s_mov_b32 s29, s17
    s_mov_b32 s30, 0x200
    s_mov_b32 s31, 0x00020000
    buffer_load_dwordx2 v[30:31], v15, s[28:31], s63 offen
    s_mov_b32 s68, s10
    s_mov_b32 s69, s11
    s_mov_b32 s70, 0x9c400
    s_mov_b32 s71, 0x00020000
    v_lshlrev_b32 v13, 4, v2
    s_cmp_lt_u32 s3, 8
    s_cselect_b32 s79, 2, 3
    s_waitcnt vmcnt(0)
    v_lshlrev_b32 v64, 16, v30
    v_and_b32 v65, 0xffff0000, v30
    v_lshlrev_b32 v66, 16, v31
    v_and_b32 v67, 0xffff0000, v31
    v_mul_f32 v64, 0xbfb8aa3b, v64
    v_mul_f32 v65, 0xbfb8aa3b, v65
    v_mul_f32 v66, 0xbfb8aa3b, v66
    v_mul_f32 v67, 0xbfb8aa3b, v67
K2_s_chunk:
    v_lshrrev_b32 v72, 9, v10
    v_and_b32 v14, 15, v72
    v_mul_u32_u24 v14, 1040, v14
    v_lshrrev_b32 v1, 5, v72
    v_subrev_u32 v1, s53, v1
    v_add_u32 v40, 5, v1
    v_min_u32 v1, v1, v40
    v_mad_u32_u24 v14, v1, s43, v14
    v_and_b32 v1, 16, v72
    v_lshl_add_u32 v14, v1, 5, v14
    v_add_u32 v14, s56, v14
    v_add_u32 v14, v14, v97
    ds_read_b128 v[52:55], v14
    buffer_load_dwordx2 v[116:117], v10, s[44:47], s87 offen
    v_mov_b32 v56, 0
    v_mov_b32 v60, 0
    v_mov_b32 v57, 0
    v_mov_b32 v61, 0
    v_mov_b32 v58, 0
    v_mov_b32 v62, 0
    v_mov_b32 v59, 0
    v_mov_b32 v63, 0
    s_waitcnt vmcnt(0) lgkmcnt(0)
    v_and_b32 v40, 0xffff0000, v52
    v_log_f32 v40, v40
    v_lshlrev_b32 v41, 1, v52
    v_and_b32 v41, 0x80000000, v41
    v_and_b32 v42, 0x3fff0000, v52
    v_or3_b32 v41, v41, v42, 2.0
    v_cmp_gt_i32 vcc, 0, v52
    s_nop 1
    v_cndmask_b32 v68, v40, v41, vcc
    v_and_b32 v40, 0xffff0000, v53
    v_log_f32 v40, v40
    v_lshlrev_b32 v41, 1, v53
    v_and_b32 v41, 0x80000000, v41
    v_and_b32 v42, 0x3fff0000, v53
    v_or3_b32 v41, v41, v42, 2.0
    v_cmp_gt_i32 vcc, 0, v53
    s_nop 1
    v_cndmask_b32 v69, v40, v41, vcc
    v_and_b32 v40, 0xffff0000, v54
    v_log_f32 v40, v40
    v_lshlrev_b32 v41, 1, v54
    v_and_b32 v41, 0x80000000, v41
    v_and_b32 v42, 0x3fff0000, v54
    v_or3_b32 v41, v41, v42, 2.0
    v_cmp_gt_i32 vcc, 0, v54
    s_nop 1
    v_cndmask_b32 v70, v40, v41, vcc
    v_and_b32 v40, 0xffff0000, v55
    v_log_f32 v40, v40
    v_lshlrev_b32 v41, 1, v55
    v_and_b32 v41, 0x80000000, v41
    v_and_b32 v42, 0x3fff0000, v55
    v_or3_b32 v41, v41, v42, 2.0
    v_cmp_gt_i32 vcc, 0, v55
    s_nop 1
    v_cndmask_b32 v71, v40, v41, vcc
    s_mov_b32 s75, 0
K2_s_blk:
    buffer_load_dwordx4 v[76:79], v13, s[68:71], s75 offen
    s_mov_b32 s74, 0
    s_waitcnt vmcnt(0)
K2_s_comp:
    v_subrev_u32 v1, s52, v76
    v_cmp_gt_u32 vcc, 158, v1
    s_nop 1
    s_mov_b64 s[76:77], vcc
K2_s_edge:
    s_cmp_eq_u64 s[76:77], 0
    s_cbranch_scc1 K2_s_comp_done
    s_ff1_i32_b64 s78, s[76:77]
    s_bitset0_b64 s[76:77], s78
    v_readlane_b32 s80, v1, s78
    s_nop 1
    v_cmp_eq_u32 vcc, s80, v72
    s_nop 1
    s_cbranch_vccz K2_s_edge
    s_lshl_b32 s78, s78, 4
    s_add_u32 s78, s78, s75
    s_add_u32 s78, s78, s74
    s_load_dword s80, s[8:9], s78
    s_lshr_b32 s81, s78, 3
    s_lshl_b32 s81, s81, 2
    s_load_dword s81, s[6:7], s81
    s_mov_b64 exec, vcc
    s_waitcnt lgkmcnt(0)
    v_mov_b32 v96, s80
    buffer_load_dwordx4 v[80:83], v[96:97], s[36:39], 0 idxen offen sc1
    s_lshl_b32 s80, s81, 16
    s_and_b32 s81, s81, 0xffff0000
    s_bitcmp1_b32 s78, 2
    s_cselect_b32 s80, s81, s80
    s_waitcnt vmcnt(0)
    v_and_b32 v40, 0xffff0000, v80
    v_log_f32 v40, v40
    v_lshlrev_b32 v41, 1, v80
    v_and_b32 v41, 0x80000000, v41
    v_and_b32 v42, 0x3fff0000, v80
    v_or3_b32 v41, v41, v42, 2.0
    v_cmp_gt_i32 vcc, 0, v80
    s_nop 1
    v_cndmask_b32 v16, v40, v41, vcc
    v_and_b32 v40, 0xffff0000, v81
    v_log_f32 v40, v40
    v_lshlrev_b32 v41, 1, v81
    v_and_b32 v41, 0x80000000, v41
    v_and_b32 v42, 0x3fff0000, v81
    v_or3_b32 v41, v41, v42, 2.0
    v_cmp_gt_i32 vcc, 0, v81
    s_nop 1
    v_cndmask_b32 v17, v40, v41, vcc
    v_and_b32 v40, 0xffff0000, v82
    v_log_f32 v40, v40
    v_lshlrev_b32 v41, 1, v82
    v_and_b32 v41, 0x80000000, v41
    v_and_b32 v42, 0x3fff0000, v82
    v_or3_b32 v41, v41, v42, 2.0
    v_cmp_gt_i32 vcc, 0, v82
    s_nop 1
    v_cndmask_b32 v18, v40, v41, vcc
    v_and_b32 v40, 0xffff0000, v83
    v_log_f32 v40, v40
    v_lshlrev_b32 v41, 1, v83
    v_and_b32 v41, 0x80000000, v41
    v_and_b32 v42, 0x3fff0000, v83
    v_or3_b32 v41, v41, v42, 2.0
    v_cmp_gt_i32 vcc, 0, v83
    s_nop 1
    v_cndmask_b32 v19, v40, v41, vcc
    v_sub_f32 v16, v16, v68
    v_sub_f32 v17, v17, v69
    v_sub_f32 v18, v18, v70
    v_sub_f32 v19, v19, v71
    v_fma_f32 v16, s80, v64, v16
    v_fma_f32 v17, s80, v65, v17
    v_fma_f32 v18, s80, v66, v18
    v_fma_f32 v19, s80, v67, v19
    v_exp_f32 v16, v16
    v_exp_f32 v17, v17
    v_exp_f32 v18, v18
    v_exp_f32 v19, v19
    v_lshlrev_b32 v24, 16, v80
    v_lshlrev_b32 v25, 16, v81
    v_lshlrev_b32 v26, 16, v82
    v_lshlrev_b32 v27, 16, v83
    v_add_f32 v16, 1.0, v16
    v_add_f32 v17, 1.0, v17
    v_add_f32 v18, 1.0, v18
    v_add_f32 v19, 1.0, v19
    v_rcp_f32 v16, v16
    v_rcp_f32 v17, v17
    v_rcp_f32 v18, v18
    v_rcp_f32 v19, v19
    s_nop 0
    v_add_f32 v56, v56, v16
    v_fma_f32 v60, v16, v24, v60
    v_add_f32 v57, v57, v17
    v_fma_f32 v61, v17, v25, v61
    v_add_f32 v58, v58, v18
    v_fma_f32 v62, v18, v26, v62
    v_add_f32 v59, v59, v19
    v_fma_f32 v63, v19, v27, v63
    s_mov_b64 exec, -1
    s_branch K2_s_edge
K2_s_comp_done:
    v_mov_b32 v76, v77
    v_mov_b32 v77, v78
    v_mov_b32 v78, v79
    s_add_u32 s74, s74, 4
    s_cmp_lt_u32 s74, 16
    s_cbranch_scc1 K2_s_comp
    s_add_u32 s75, s75, 1024
    s_cmp_lt_u32 s75, 640000
    s_cbranch_scc1 K2_s_blk
    v_add_f32 v56, 0x358637bd, v56
    v_add_f32 v57, 0x358637bd, v57
    v_add_f32 v58, 0x358637bd, v58
    v_add_f32 v59, 0x358637bd, v59
    v_rcp_f32 v56, v56
    v_rcp_f32 v57, v57
    v_rcp_f32 v58, v58
    v_rcp_f32 v59, v59
    v_lshlrev_b32 v24, 16, v52
    v_lshlrev_b32 v25, 16, v53
    v_lshlrev_b32 v26, 16, v54
    v_lshlrev_b32 v27, 16, v55
    v_lshlrev_b32 v28, 16, v116
    v_and_b32 v29, 0xffff0000, v116
    v_lshlrev_b32 v30, 16, v117
    v_and_b32 v31, 0xffff0000, v117
    v_fma_f32 v24, v60, v56, v24
    v_mul_f32 v40, 0, v24
    v_cmp_lt_f32 vcc, 0, v24
    s_nop 1
    v_cndmask_b32 v24, v40, v24, vcc
    v_add_f32 v24, v24, v28
    v_fma_f32 v25, v61, v57, v25
    v_mul_f32 v40, 0, v25
    v_cmp_lt_f32 vcc, 0, v25
    s_nop 1
    v_cndmask_b32 v25, v40, v25, vcc
    v_add_f32 v25, v25, v29
    v_fma_f32 v26, v62, v58, v26
    v_mul_f32 v40, 0, v26
    v_cmp_lt_f32 vcc, 0, v26
    s_nop 1
    v_cndmask_b32 v26, v40, v26, vcc
    v_add_f32 v26, v26, v30
    v_fma_f32 v27, v63, v59, v27
    v_mul_f32 v40, 0, v27
    v_cmp_lt_f32 vcc, 0, v27
    s_nop 1
    v_cndmask_b32 v27, v40, v27, vcc
    v_add_f32 v27, v27, v31
    v_cvt_pk_bf16_f32 v28, v24, v25
    v_cvt_pk_bf16_f32 v29, v26, v27
    buffer_store_dwordx2 v[28:29], v10, s[48:51], s87 offen
    s_waitcnt vmcnt(0)
    v_mov_b32 v10, v11
    v_mov_b32 v11, v12
    s_sub_u32 s79, s79, 1
    s_cmp_lg_u32 s79, 0
    s_cbranch_scc1 K2_s_chunk
    s_endpgm
K_code_end:
.section .rodata,"a"
.p2align 6
.amdhsa_kernel standalone__edge_featured_mpnn_gatedgcn__graph_kernel
  .amdhsa_next_free_vgpr 128
  .amdhsa_next_free_sgpr 102
  .amdhsa_accum_offset 128
  .amdhsa_group_segment_fixed_size 0
  .amdhsa_kernarg_size 96
  .amdhsa_user_sgpr_count 2
  .amdhsa_user_sgpr_kernarg_segment_ptr 1
  .amdhsa_system_sgpr_workgroup_id_x 1
.end_amdhsa_kernel
```
